```python
import torch

def _softmax(x, axis=-1):
    return torch.softmax(x, dim=axis)
def _gelu(x):
    return torch.nn.functional.gelu(x, approximate="tanh")
def _silu(x):
    return torch.nn.functional.silu(x)
def _sigmoid(x):
    return torch.sigmoid(x)
def _layernorm(x, axis=-1, eps=1e-5):
    m = x.mean(dim=axis, keepdim=True)
    v = x.var(dim=axis, keepdim=True, unbiased=False)
    return (x - m) / torch.sqrt(v + eps)
def _scatter_add(tgt, idx, src, axis=0):
    return tgt.clone().index_add_(axis, idx, src)
def _segment_sum(src, seg, n):
    out = torch.zeros((n,) + src.shape[1:], dtype=src.dtype)
    return out.index_add_(0, seg, src)
def _pad(x, pw):
    flat = tuple(v for pair in reversed(pw) for v in pair)
    return torch.nn.functional.pad(x, flat)

kernel_name = 'interleave_layers__ssm_conv_s4__sliding_block__prompt'

def setup_inputs():

    _w = (lambda a: (lambda t: t.to(torch.bfloat16) if t.is_floating_point() else t)(torch.as_tensor(a)))
    def _A_setup():
        B, L, D, N = 1, 2048, 512, 128
        A_re = -(lambda _x: torch.exp(torch.as_tensor(_x)))((lambda *s: torch.randn(*s, dtype=torch.bfloat16) * 1.6)(D, N))
        A_im = torch.pi * (lambda *s: torch.randn(*s, dtype=torch.bfloat16) * 0.05)(D, N)
        B_re = (lambda *s: torch.randn(*s, dtype=torch.bfloat16) * 0.05)(D, N)
        B_im = (lambda *s: torch.randn(*s, dtype=torch.bfloat16) * 0.05)(D, N)
        C_re = (lambda *s: torch.randn(*s, dtype=torch.bfloat16) * 0.05)(D, N)
        C_im = (lambda *s: torch.randn(*s, dtype=torch.bfloat16) * 0.05)(D, N)
        log_dt = (lambda *s: torch.randn(*s, dtype=torch.bfloat16) * 0.05)(D) * 0.5 - 4.0
        Dskip = (lambda *s: torch.randn(*s, dtype=torch.bfloat16) * 0.05)(D)
        return {
            "u": _w((lambda *s: torch.randn(*s, dtype=torch.bfloat16) * 0.05)(B, L, D)),
            "A_re": _w(A_re),
            "A_im": _w(A_im),
            "B_re": _w(B_re),
            "B_im": _w(B_im),
            "C_re": _w(C_re),
            "C_im": _w(C_im),
            "log_dt": _w(log_dt),
            "Dskip": _w(Dskip),
        }
    _A_in = _A_setup()

    def _B_setup():
        B, S, D = 1, 2048, 512
        return {
            "x": _w((lambda *s: torch.randn(*s, dtype=torch.bfloat16) * 0.05)(B, S, D)),
            "wqkv": _w((lambda *s: torch.randn(*s, dtype=torch.bfloat16) * 0.05)(D, 3 * D)),
            "wo": _w((lambda *s: torch.randn(*s, dtype=torch.bfloat16) * 0.05)(D, D)),
        }
    _B_in = _B_setup()

    return {
        "A_u": _A_in["u"],
        "A_A_re": _A_in["A_re"],
        "A_A_im": _A_in["A_im"],
        "A_B_re": _A_in["B_re"],
        "A_B_im": _A_in["B_im"],
        "A_C_re": _A_in["C_re"],
        "A_C_im": _A_in["C_im"],
        "A_log_dt": _A_in["log_dt"],
        "A_Dskip": _A_in["Dskip"],
        "B_x": _B_in["x"],
        "B_wqkv": _B_in["wqkv"],
        "B_wo": _B_in["wo"],
    }

def reference(A_u, A_A_re, A_A_im, A_B_re, A_B_im, A_C_re, A_C_im, A_log_dt, A_Dskip, B_x, B_wqkv, B_wo):
    def _A_ref(u, A_re, A_im, B_re, B_im, C_re, C_im, log_dt, Dskip):
        Bsz, L, D = u.shape
        dt = torch.exp(log_dt)[:, None]
        A = A_re + 1j * A_im
        Bc = B_re + 1j * B_im
        Cc = C_re + 1j * C_im
        logdA = dt * A
        dB = dt * Bc
        l = (lambda x, dt: x.to(dt))(torch.arange(L), A_re.dtype)
        P = torch.exp(logdA[:, :, None] * l[None, None, :])
        K = torch.einsum("dn,dnl,dn->dl", Cc, P, dB).real
        L2 = 2 * L
        Kp = _pad(K, ((0, 0), (0, L)))
        up = (lambda x, *d: x.permute(*d))(u, 0, 2, 1)
        up = _pad(up, ((0, 0), (0, 0), (0, L)))
        Kf = (lambda x, axes=(-2,-1): torch.fft.rfft2(x.float(), dim=axes))(Kp[:, None, :], axes=(-2, -1))
        Uf = (lambda x, axes=(-2,-1): torch.fft.rfft2(x.float(), dim=axes))(up[:, :, None, :], axes=(-2, -1))
        Yf = Uf * Kf[None, :, :, :]
        y = (lambda x, s, axes=(-2,-1): torch.fft.irfft2(x, s=s, dim=axes).to(torch.bfloat16))(Yf, (1, L2), axes=(-2, -1))[:, :, 0, :L]
        y = (lambda x, *d: x.permute(*d))(y, 0, 2, 1) + u * Dskip[None, None, :]
        return y

    def _B_ref(x, wqkv, wo):
        B, S, D = x.shape
        H = 32; Dh = D // H; W = 256
        qkv = (lambda x, *d: x.permute(*d))((x @ wqkv).reshape(B, S, 3, H, Dh), 2, 0, 3, 1, 4)
        q, k, v = qkv[0], qkv[1], qkv[2]
        scores = torch.einsum("bhqd,bhkd->bhqk", q, k) * (Dh ** -0.5)
        idx = torch.arange(S)
        mask = (idx[:, None] - idx[None, :] >= 0) & (idx[:, None] - idx[None, :] < W)
        scores = torch.where(mask[None, None], scores, -1e9)
        p = _softmax(scores, axis=-1)
        o = torch.einsum("bhqk,bhkd->bhqd", p, v)
        return (lambda x, *d: x.permute(*d))(o, 0, 2, 1, 3).reshape(B, S, D) @ wo

    x = A_u
    x = x + _A_ref(_layernorm(x, axis=-1), A_A_re, A_A_im, A_B_re, A_B_im, A_C_re, A_C_im, A_log_dt, A_Dskip)
    x = x + _B_ref(_layernorm(x, axis=-1), B_wqkv, B_wo)
    x = x + _A_ref(_layernorm(x, axis=-1), A_A_re, A_A_im, A_B_re, A_B_im, A_C_re, A_C_im, A_log_dt, A_Dskip)
    x = x + _B_ref(_layernorm(x, axis=-1), B_wqkv, B_wo)
    return x
```

```asm
; @launch kernel=prep_kernel grid=(640,1,1) block=(256,1,1) lds=34816
; @launch kernel=conv1_kernel grid=(512,1,1) block=(256,1,1) lds=52800
; @launch kernel=qkv1_kernel grid=(256,1,1) block=(256,1,1) lds=65536
; @launch kernel=attn_kernel grid=(512,1,1) block=(256,1,1) lds=0
; @launch kernel=oproj1_kernel grid=(256,1,1) block=(256,1,1) lds=36864
; @launch kernel=conv2_kernel grid=(512,1,1) block=(256,1,1) lds=52800
; @launch kernel=qkv2_kernel grid=(256,1,1) block=(256,1,1) lds=65536
; @launch kernel=attn_kernel grid=(512,1,1) block=(256,1,1) lds=0
; @launch kernel=oproj2_kernel grid=(256,1,1) block=(256,1,1) lds=32768
.amdgcn_target "amdgcn-amd-amdhsa--gfx950"
.text
.globl prep_kernel
.p2align 8
.type prep_kernel,@function
prep_kernel:
    s_load_dwordx2 s[8:9], s[0:1], 112
    s_mov_b32 s10, 25165824
    s_mov_b32 s11, 0x00020000
    s_mov_b32 s20, 0x05040100
    s_mov_b32 s21, 0x07060302
    v_lshrrev_b32 v1, 6, v0
    v_and_b32 v2, 63, v0
    s_cmp_lt_u32 s2, 512
    s_cbranch_scc1 L_kgen
    s_cmp_lt_u32 s2, 576
    s_cbranch_scc1 L_xt
    s_cmp_lt_u32 s2, 640
    s_cbranch_scc0 L_prep_end
    s_sub_u32 s3, s2, 576
    s_cmp_lt_u32 s3, 48
    s_cbranch_scc0 L_wo
    s_load_dwordx2 s[12:13], s[0:1], 80
    s_mov_b32 s14, 1572864
    s_mov_b32 s15, 0x00020000
    s_mov_b32 s22, 3072
    s_mov_b32 s23, 13631488
    s_mul_i32 s24, s3, 21846
    s_lshr_b32 s24, s24, 16
    s_lshr_b32 s24, s24, 2
    s_mul_i32 s25, s24, 12
    s_sub_u32 s25, s3, s25
    s_branch L_wt
L_wo:
    s_load_dwordx2 s[12:13], s[0:1], 88
    s_mov_b32 s14, 524288
    s_mov_b32 s15, 0x00020000
    s_sub_u32 s3, s3, 48
    s_mov_b32 s22, 1024
    s_mov_b32 s23, 15728640
    s_lshr_b32 s24, s3, 2
    s_and_b32 s25, s3, 3
L_wt:
    s_waitcnt lgkmcnt(0)
    v_and_b32 v3, 15, v0
    v_lshrrev_b32 v4, 4, v0
    s_lshl_b32 s26, s24, 7
    s_lshl_b32 s27, s25, 7
    v_lshlrev_b32 v5, 3, v4
    v_add_u32 v5, s26, v5
    v_lshlrev_b32 v6, 3, v3
    v_add_u32 v6, s27, v6
    v_mul_lo_u32 v7, v5, s22
    v_lshl_add_u32 v7, v6, 1, v7
    buffer_load_dwordx4 v[16:19], v7, s[12:15], 0 offen
    v_add_u32 v7, s22, v7
    buffer_load_dwordx4 v[20:23], v7, s[12:15], 0 offen
    v_add_u32 v7, s22, v7
    buffer_load_dwordx4 v[24:27], v7, s[12:15], 0 offen
    v_add_u32 v7, s22, v7
    buffer_load_dwordx4 v[28:31], v7, s[12:15], 0 offen
    v_add_u32 v7, s22, v7
    buffer_load_dwordx4 v[32:35], v7, s[12:15], 0 offen
    v_add_u32 v7, s22, v7
    buffer_load_dwordx4 v[36:39], v7, s[12:15], 0 offen
    v_add_u32 v7, s22, v7
    buffer_load_dwordx4 v[40:43], v7, s[12:15], 0 offen
    v_add_u32 v7, s22, v7
    buffer_load_dwordx4 v[44:47], v7, s[12:15], 0 offen
    v_add_u32 v7, s22, v7
    v_lshrrev_b32 v8, 4, v6
    v_lshlrev_b32 v8, 4, v8
    v_lshrrev_b32 v9, 5, v5
    v_add_u32 v8, v8, v9
    v_lshlrev_b32 v8, 10, v8
    v_bfe_u32 v9, v5, 3, 2
    v_lshlrev_b32 v9, 4, v9
    v_and_b32 v10, 15, v6
    v_add_u32 v9, v9, v10
    v_lshl_add_u32 v8, v9, 4, v8
    s_waitcnt vmcnt(0)
    v_perm_b32 v48, v20, v16, s20
    v_perm_b32 v49, v28, v24, s20
    v_perm_b32 v50, v36, v32, s20
    v_perm_b32 v51, v44, v40, s20
    v_perm_b32 v52, v20, v16, s21
    v_perm_b32 v53, v28, v24, s21
    v_perm_b32 v54, v36, v32, s21
    v_perm_b32 v55, v44, v40, s21
    v_perm_b32 v56, v21, v17, s20
    v_perm_b32 v57, v29, v25, s20
    v_perm_b32 v58, v37, v33, s20
    v_perm_b32 v59, v45, v41, s20
    v_perm_b32 v60, v21, v17, s21
    v_perm_b32 v61, v29, v25, s21
    v_perm_b32 v62, v37, v33, s21
    v_perm_b32 v63, v45, v41, s21
    v_perm_b32 v64, v22, v18, s20
    v_perm_b32 v65, v30, v26, s20
    v_perm_b32 v66, v38, v34, s20
    v_perm_b32 v67, v46, v42, s20
    v_perm_b32 v68, v22, v18, s21
    v_perm_b32 v69, v30, v26, s21
    v_perm_b32 v70, v38, v34, s21
    v_perm_b32 v71, v46, v42, s21
    v_perm_b32 v72, v23, v19, s20
    v_perm_b32 v73, v31, v27, s20
    v_perm_b32 v74, v39, v35, s20
    v_perm_b32 v75, v47, v43, s20
    v_perm_b32 v76, v23, v19, s21
    v_perm_b32 v77, v31, v27, s21
    v_perm_b32 v78, v39, v35, s21
    v_perm_b32 v79, v47, v43, s21
    buffer_store_dwordx4 v[48:51], v8, s[8:11], s23 offen offset:0
    buffer_store_dwordx4 v[52:55], v8, s[8:11], s23 offen offset:16
    buffer_store_dwordx4 v[56:59], v8, s[8:11], s23 offen offset:32
    buffer_store_dwordx4 v[60:63], v8, s[8:11], s23 offen offset:48
    buffer_store_dwordx4 v[64:67], v8, s[8:11], s23 offen offset:64
    buffer_store_dwordx4 v[68:71], v8, s[8:11], s23 offen offset:80
    buffer_store_dwordx4 v[72:75], v8, s[8:11], s23 offen offset:96
    buffer_store_dwordx4 v[76:79], v8, s[8:11], s23 offen offset:112
    s_branch L_prep_end
L_xt:
    s_load_dwordx2 s[12:13], s[0:1], 0
    s_mov_b32 s14, 2097152
    s_mov_b32 s15, 0x00020000
    s_sub_u32 s3, s2, 512
    s_lshl_b32 s3, s3, 5
    s_waitcnt lgkmcnt(0)
    v_lshlrev_b32 v3, 3, v1
    v_add_u32 v3, s3, v3
    v_lshlrev_b32 v4, 10, v3
    v_lshl_add_u32 v4, v2, 4, v4
    buffer_load_dwordx4 v[16:19], v4, s[12:15], 0 offen offset:0
    buffer_load_dwordx4 v[20:23], v4, s[12:15], 0 offen offset:1024
    buffer_load_dwordx4 v[24:27], v4, s[12:15], 0 offen offset:2048
    buffer_load_dwordx4 v[28:31], v4, s[12:15], 0 offen offset:3072
    v_add_u32 v4, 4096, v4
    buffer_load_dwordx4 v[32:35], v4, s[12:15], 0 offen offset:0
    buffer_load_dwordx4 v[36:39], v4, s[12:15], 0 offen offset:1024
    buffer_load_dwordx4 v[40:43], v4, s[12:15], 0 offen offset:2048
    buffer_load_dwordx4 v[44:47], v4, s[12:15], 0 offen offset:3072
    v_lshlrev_b32 v5, 15, v2
    v_lshl_add_u32 v5, v3, 1, v5
    s_waitcnt vmcnt(0)
    v_perm_b32 v48, v20, v16, s20
    v_perm_b32 v49, v28, v24, s20
    v_perm_b32 v50, v36, v32, s20
    v_perm_b32 v51, v44, v40, s20
    v_perm_b32 v52, v20, v16, s21
    v_perm_b32 v53, v28, v24, s21
    v_perm_b32 v54, v36, v32, s21
    v_perm_b32 v55, v44, v40, s21
    v_perm_b32 v56, v21, v17, s20
    v_perm_b32 v57, v29, v25, s20
    v_perm_b32 v58, v37, v33, s20
    v_perm_b32 v59, v45, v41, s20
    v_perm_b32 v60, v21, v17, s21
    v_perm_b32 v61, v29, v25, s21
    v_perm_b32 v62, v37, v33, s21
    v_perm_b32 v63, v45, v41, s21
    v_perm_b32 v64, v22, v18, s20
    v_perm_b32 v65, v30, v26, s20
    v_perm_b32 v66, v38, v34, s20
    v_perm_b32 v67, v46, v42, s20
    v_perm_b32 v68, v22, v18, s21
    v_perm_b32 v69, v30, v26, s21
    v_perm_b32 v70, v38, v34, s21
    v_perm_b32 v71, v46, v42, s21
    v_perm_b32 v72, v23, v19, s20
    v_perm_b32 v73, v31, v27, s20
    v_perm_b32 v74, v39, v35, s20
    v_perm_b32 v75, v47, v43, s20
    v_perm_b32 v76, v23, v19, s21
    v_perm_b32 v77, v31, v27, s21
    v_perm_b32 v78, v39, v35, s21
    v_perm_b32 v79, v47, v43, s21
    buffer_store_dwordx4 v[48:51], v5, s[8:11], 0 offen
    v_add_u32 v5, 4096, v5
    buffer_store_dwordx4 v[52:55], v5, s[8:11], 0 offen
    v_add_u32 v5, 4096, v5
    buffer_store_dwordx4 v[56:59], v5, s[8:11], 0 offen
    v_add_u32 v5, 4096, v5
    buffer_store_dwordx4 v[60:63], v5, s[8:11], 0 offen
    v_add_u32 v5, 4096, v5
    buffer_store_dwordx4 v[64:67], v5, s[8:11], 0 offen
    v_add_u32 v5, 4096, v5
    buffer_store_dwordx4 v[68:71], v5, s[8:11], 0 offen
    v_add_u32 v5, 4096, v5
    buffer_store_dwordx4 v[72:75], v5, s[8:11], 0 offen
    v_add_u32 v5, 4096, v5
    buffer_store_dwordx4 v[76:79], v5, s[8:11], 0 offen
    v_add_u32 v5, 4096, v5
    v_mov_b32 v80, 0
    v_mov_b32 v88, 0
    v_lshlrev_b32 v6, 16, v16
    v_and_b32 v7, 0xffff0000, v16
    v_add_f32 v80, v80, v6
    v_fmac_f32 v88, v6, v6
    v_add_f32 v80, v80, v7
    v_fmac_f32 v88, v7, v7
    v_lshlrev_b32 v6, 16, v17
    v_and_b32 v7, 0xffff0000, v17
    v_add_f32 v80, v80, v6
    v_fmac_f32 v88, v6, v6
    v_add_f32 v80, v80, v7
    v_fmac_f32 v88, v7, v7
    v_lshlrev_b32 v6, 16, v18
    v_and_b32 v7, 0xffff0000, v18
    v_add_f32 v80, v80, v6
    v_fmac_f32 v88, v6, v6
    v_add_f32 v80, v80, v7
    v_fmac_f32 v88, v7, v7
    v_lshlrev_b32 v6, 16, v19
    v_and_b32 v7, 0xffff0000, v19
    v_add_f32 v80, v80, v6
    v_fmac_f32 v88, v6, v6
    v_add_f32 v80, v80, v7
    v_fmac_f32 v88, v7, v7
    v_mov_b32 v81, 0
    v_mov_b32 v89, 0
    v_lshlrev_b32 v6, 16, v20
    v_and_b32 v7, 0xffff0000, v20
    v_add_f32 v81, v81, v6
    v_fmac_f32 v89, v6, v6
    v_add_f32 v81, v81, v7
    v_fmac_f32 v89, v7, v7
    v_lshlrev_b32 v6, 16, v21
    v_and_b32 v7, 0xffff0000, v21
    v_add_f32 v81, v81, v6
    v_fmac_f32 v89, v6, v6
    v_add_f32 v81, v81, v7
    v_fmac_f32 v89, v7, v7
    v_lshlrev_b32 v6, 16, v22
    v_and_b32 v7, 0xffff0000, v22
    v_add_f32 v81, v81, v6
    v_fmac_f32 v89, v6, v6
    v_add_f32 v81, v81, v7
    v_fmac_f32 v89, v7, v7
    v_lshlrev_b32 v6, 16, v23
    v_and_b32 v7, 0xffff0000, v23
    v_add_f32 v81, v81, v6
    v_fmac_f32 v89, v6, v6
    v_add_f32 v81, v81, v7
    v_fmac_f32 v89, v7, v7
    v_mov_b32 v82, 0
    v_mov_b32 v90, 0
    v_lshlrev_b32 v6, 16, v24
    v_and_b32 v7, 0xffff0000, v24
    v_add_f32 v82, v82, v6
    v_fmac_f32 v90, v6, v6
    v_add_f32 v82, v82, v7
    v_fmac_f32 v90, v7, v7
    v_lshlrev_b32 v6, 16, v25
    v_and_b32 v7, 0xffff0000, v25
    v_add_f32 v82, v82, v6
    v_fmac_f32 v90, v6, v6
    v_add_f32 v82, v82, v7
    v_fmac_f32 v90, v7, v7
    v_lshlrev_b32 v6, 16, v26
    v_and_b32 v7, 0xffff0000, v26
    v_add_f32 v82, v82, v6
    v_fmac_f32 v90, v6, v6
    v_add_f32 v82, v82, v7
    v_fmac_f32 v90, v7, v7
    v_lshlrev_b32 v6, 16, v27
    v_and_b32 v7, 0xffff0000, v27
    v_add_f32 v82, v82, v6
    v_fmac_f32 v90, v6, v6
    v_add_f32 v82, v82, v7
    v_fmac_f32 v90, v7, v7
    v_mov_b32 v83, 0
    v_mov_b32 v91, 0
    v_lshlrev_b32 v6, 16, v28
    v_and_b32 v7, 0xffff0000, v28
    v_add_f32 v83, v83, v6
    v_fmac_f32 v91, v6, v6
    v_add_f32 v83, v83, v7
    v_fmac_f32 v91, v7, v7
    v_lshlrev_b32 v6, 16, v29
    v_and_b32 v7, 0xffff0000, v29
    v_add_f32 v83, v83, v6
    v_fmac_f32 v91, v6, v6
    v_add_f32 v83, v83, v7
    v_fmac_f32 v91, v7, v7
    v_lshlrev_b32 v6, 16, v30
    v_and_b32 v7, 0xffff0000, v30
    v_add_f32 v83, v83, v6
    v_fmac_f32 v91, v6, v6
    v_add_f32 v83, v83, v7
    v_fmac_f32 v91, v7, v7
    v_lshlrev_b32 v6, 16, v31
    v_and_b32 v7, 0xffff0000, v31
    v_add_f32 v83, v83, v6
    v_fmac_f32 v91, v6, v6
    v_add_f32 v83, v83, v7
    v_fmac_f32 v91, v7, v7
    v_mov_b32 v84, 0
    v_mov_b32 v92, 0
    v_lshlrev_b32 v6, 16, v32
    v_and_b32 v7, 0xffff0000, v32
    v_add_f32 v84, v84, v6
    v_fmac_f32 v92, v6, v6
    v_add_f32 v84, v84, v7
    v_fmac_f32 v92, v7, v7
    v_lshlrev_b32 v6, 16, v33
    v_and_b32 v7, 0xffff0000, v33
    v_add_f32 v84, v84, v6
    v_fmac_f32 v92, v6, v6
    v_add_f32 v84, v84, v7
    v_fmac_f32 v92, v7, v7
    v_lshlrev_b32 v6, 16, v34
    v_and_b32 v7, 0xffff0000, v34
    v_add_f32 v84, v84, v6
    v_fmac_f32 v92, v6, v6
    v_add_f32 v84, v84, v7
    v_fmac_f32 v92, v7, v7
    v_lshlrev_b32 v6, 16, v35
    v_and_b32 v7, 0xffff0000, v35
    v_add_f32 v84, v84, v6
    v_fmac_f32 v92, v6, v6
    v_add_f32 v84, v84, v7
    v_fmac_f32 v92, v7, v7
    v_mov_b32 v85, 0
    v_mov_b32 v93, 0
    v_lshlrev_b32 v6, 16, v36
    v_and_b32 v7, 0xffff0000, v36
    v_add_f32 v85, v85, v6
    v_fmac_f32 v93, v6, v6
    v_add_f32 v85, v85, v7
    v_fmac_f32 v93, v7, v7
    v_lshlrev_b32 v6, 16, v37
    v_and_b32 v7, 0xffff0000, v37
    v_add_f32 v85, v85, v6
    v_fmac_f32 v93, v6, v6
    v_add_f32 v85, v85, v7
    v_fmac_f32 v93, v7, v7
    v_lshlrev_b32 v6, 16, v38
    v_and_b32 v7, 0xffff0000, v38
    v_add_f32 v85, v85, v6
    v_fmac_f32 v93, v6, v6
    v_add_f32 v85, v85, v7
    v_fmac_f32 v93, v7, v7
    v_lshlrev_b32 v6, 16, v39
    v_and_b32 v7, 0xffff0000, v39
    v_add_f32 v85, v85, v6
    v_fmac_f32 v93, v6, v6
    v_add_f32 v85, v85, v7
    v_fmac_f32 v93, v7, v7
    v_mov_b32 v86, 0
    v_mov_b32 v94, 0
    v_lshlrev_b32 v6, 16, v40
    v_and_b32 v7, 0xffff0000, v40
    v_add_f32 v86, v86, v6
    v_fmac_f32 v94, v6, v6
    v_add_f32 v86, v86, v7
    v_fmac_f32 v94, v7, v7
    v_lshlrev_b32 v6, 16, v41
    v_and_b32 v7, 0xffff0000, v41
    v_add_f32 v86, v86, v6
    v_fmac_f32 v94, v6, v6
    v_add_f32 v86, v86, v7
    v_fmac_f32 v94, v7, v7
    v_lshlrev_b32 v6, 16, v42
    v_and_b32 v7, 0xffff0000, v42
    v_add_f32 v86, v86, v6
    v_fmac_f32 v94, v6, v6
    v_add_f32 v86, v86, v7
    v_fmac_f32 v94, v7, v7
    v_lshlrev_b32 v6, 16, v43
    v_and_b32 v7, 0xffff0000, v43
    v_add_f32 v86, v86, v6
    v_fmac_f32 v94, v6, v6
    v_add_f32 v86, v86, v7
    v_fmac_f32 v94, v7, v7
    v_mov_b32 v87, 0
    v_mov_b32 v95, 0
    v_lshlrev_b32 v6, 16, v44
    v_and_b32 v7, 0xffff0000, v44
    v_add_f32 v87, v87, v6
    v_fmac_f32 v95, v6, v6
    v_add_f32 v87, v87, v7
    v_fmac_f32 v95, v7, v7
    v_lshlrev_b32 v6, 16, v45
    v_and_b32 v7, 0xffff0000, v45
    v_add_f32 v87, v87, v6
    v_fmac_f32 v95, v6, v6
    v_add_f32 v87, v87, v7
    v_fmac_f32 v95, v7, v7
    v_lshlrev_b32 v6, 16, v46
    v_and_b32 v7, 0xffff0000, v46
    v_add_f32 v87, v87, v6
    v_fmac_f32 v95, v6, v6
    v_add_f32 v87, v87, v7
    v_fmac_f32 v95, v7, v7
    v_lshlrev_b32 v6, 16, v47
    v_and_b32 v7, 0xffff0000, v47
    v_add_f32 v87, v87, v6
    v_fmac_f32 v95, v6, v6
    v_add_f32 v87, v87, v7
    v_fmac_f32 v95, v7, v7
    v_add_f32_dpp v80, v80, v80 row_shr:1 row_mask:0xf bank_mask:0xf bound_ctrl:0
    v_add_f32_dpp v81, v81, v81 row_shr:1 row_mask:0xf bank_mask:0xf bound_ctrl:0
    v_add_f32_dpp v82, v82, v82 row_shr:1 row_mask:0xf bank_mask:0xf bound_ctrl:0
    v_add_f32_dpp v83, v83, v83 row_shr:1 row_mask:0xf bank_mask:0xf bound_ctrl:0
    v_add_f32_dpp v84, v84, v84 row_shr:1 row_mask:0xf bank_mask:0xf bound_ctrl:0
    v_add_f32_dpp v85, v85, v85 row_shr:1 row_mask:0xf bank_mask:0xf bound_ctrl:0
    v_add_f32_dpp v86, v86, v86 row_shr:1 row_mask:0xf bank_mask:0xf bound_ctrl:0
    v_add_f32_dpp v87, v87, v87 row_shr:1 row_mask:0xf bank_mask:0xf bound_ctrl:0
    v_add_f32_dpp v88, v88, v88 row_shr:1 row_mask:0xf bank_mask:0xf bound_ctrl:0
    v_add_f32_dpp v89, v89, v89 row_shr:1 row_mask:0xf bank_mask:0xf bound_ctrl:0
    v_add_f32_dpp v90, v90, v90 row_shr:1 row_mask:0xf bank_mask:0xf bound_ctrl:0
    v_add_f32_dpp v91, v91, v91 row_shr:1 row_mask:0xf bank_mask:0xf bound_ctrl:0
    v_add_f32_dpp v92, v92, v92 row_shr:1 row_mask:0xf bank_mask:0xf bound_ctrl:0
    v_add_f32_dpp v93, v93, v93 row_shr:1 row_mask:0xf bank_mask:0xf bound_ctrl:0
    v_add_f32_dpp v94, v94, v94 row_shr:1 row_mask:0xf bank_mask:0xf bound_ctrl:0
    v_add_f32_dpp v95, v95, v95 row_shr:1 row_mask:0xf bank_mask:0xf bound_ctrl:0
    v_add_f32_dpp v80, v80, v80 row_shr:2 row_mask:0xf bank_mask:0xf bound_ctrl:0
    v_add_f32_dpp v81, v81, v81 row_shr:2 row_mask:0xf bank_mask:0xf bound_ctrl:0
    v_add_f32_dpp v82, v82, v82 row_shr:2 row_mask:0xf bank_mask:0xf bound_ctrl:0
    v_add_f32_dpp v83, v83, v83 row_shr:2 row_mask:0xf bank_mask:0xf bound_ctrl:0
    v_add_f32_dpp v84, v84, v84 row_shr:2 row_mask:0xf bank_mask:0xf bound_ctrl:0
    v_add_f32_dpp v85, v85, v85 row_shr:2 row_mask:0xf bank_mask:0xf bound_ctrl:0
    v_add_f32_dpp v86, v86, v86 row_shr:2 row_mask:0xf bank_mask:0xf bound_ctrl:0
    v_add_f32_dpp v87, v87, v87 row_shr:2 row_mask:0xf bank_mask:0xf bound_ctrl:0
    v_add_f32_dpp v88, v88, v88 row_shr:2 row_mask:0xf bank_mask:0xf bound_ctrl:0
    v_add_f32_dpp v89, v89, v89 row_shr:2 row_mask:0xf bank_mask:0xf bound_ctrl:0
    v_add_f32_dpp v90, v90, v90 row_shr:2 row_mask:0xf bank_mask:0xf bound_ctrl:0
    v_add_f32_dpp v91, v91, v91 row_shr:2 row_mask:0xf bank_mask:0xf bound_ctrl:0
    v_add_f32_dpp v92, v92, v92 row_shr:2 row_mask:0xf bank_mask:0xf bound_ctrl:0
    v_add_f32_dpp v93, v93, v93 row_shr:2 row_mask:0xf bank_mask:0xf bound_ctrl:0
    v_add_f32_dpp v94, v94, v94 row_shr:2 row_mask:0xf bank_mask:0xf bound_ctrl:0
    v_add_f32_dpp v95, v95, v95 row_shr:2 row_mask:0xf bank_mask:0xf bound_ctrl:0
    v_add_f32_dpp v80, v80, v80 row_shr:4 row_mask:0xf bank_mask:0xf bound_ctrl:0
    v_add_f32_dpp v81, v81, v81 row_shr:4 row_mask:0xf bank_mask:0xf bound_ctrl:0
    v_add_f32_dpp v82, v82, v82 row_shr:4 row_mask:0xf bank_mask:0xf bound_ctrl:0
    v_add_f32_dpp v83, v83, v83 row_shr:4 row_mask:0xf bank_mask:0xf bound_ctrl:0
    v_add_f32_dpp v84, v84, v84 row_shr:4 row_mask:0xf bank_mask:0xf bound_ctrl:0
    v_add_f32_dpp v85, v85, v85 row_shr:4 row_mask:0xf bank_mask:0xf bound_ctrl:0
    v_add_f32_dpp v86, v86, v86 row_shr:4 row_mask:0xf bank_mask:0xf bound_ctrl:0
    v_add_f32_dpp v87, v87, v87 row_shr:4 row_mask:0xf bank_mask:0xf bound_ctrl:0
    v_add_f32_dpp v88, v88, v88 row_shr:4 row_mask:0xf bank_mask:0xf bound_ctrl:0
    v_add_f32_dpp v89, v89, v89 row_shr:4 row_mask:0xf bank_mask:0xf bound_ctrl:0
    v_add_f32_dpp v90, v90, v90 row_shr:4 row_mask:0xf bank_mask:0xf bound_ctrl:0
    v_add_f32_dpp v91, v91, v91 row_shr:4 row_mask:0xf bank_mask:0xf bound_ctrl:0
    v_add_f32_dpp v92, v92, v92 row_shr:4 row_mask:0xf bank_mask:0xf bound_ctrl:0
    v_add_f32_dpp v93, v93, v93 row_shr:4 row_mask:0xf bank_mask:0xf bound_ctrl:0
    v_add_f32_dpp v94, v94, v94 row_shr:4 row_mask:0xf bank_mask:0xf bound_ctrl:0
    v_add_f32_dpp v95, v95, v95 row_shr:4 row_mask:0xf bank_mask:0xf bound_ctrl:0
    v_add_f32_dpp v80, v80, v80 row_shr:8 row_mask:0xf bank_mask:0xf bound_ctrl:0
    v_add_f32_dpp v81, v81, v81 row_shr:8 row_mask:0xf bank_mask:0xf bound_ctrl:0
    v_add_f32_dpp v82, v82, v82 row_shr:8 row_mask:0xf bank_mask:0xf bound_ctrl:0
    v_add_f32_dpp v83, v83, v83 row_shr:8 row_mask:0xf bank_mask:0xf bound_ctrl:0
    v_add_f32_dpp v84, v84, v84 row_shr:8 row_mask:0xf bank_mask:0xf bound_ctrl:0
    v_add_f32_dpp v85, v85, v85 row_shr:8 row_mask:0xf bank_mask:0xf bound_ctrl:0
    v_add_f32_dpp v86, v86, v86 row_shr:8 row_mask:0xf bank_mask:0xf bound_ctrl:0
    v_add_f32_dpp v87, v87, v87 row_shr:8 row_mask:0xf bank_mask:0xf bound_ctrl:0
    v_add_f32_dpp v88, v88, v88 row_shr:8 row_mask:0xf bank_mask:0xf bound_ctrl:0
    v_add_f32_dpp v89, v89, v89 row_shr:8 row_mask:0xf bank_mask:0xf bound_ctrl:0
    v_add_f32_dpp v90, v90, v90 row_shr:8 row_mask:0xf bank_mask:0xf bound_ctrl:0
    v_add_f32_dpp v91, v91, v91 row_shr:8 row_mask:0xf bank_mask:0xf bound_ctrl:0
    v_add_f32_dpp v92, v92, v92 row_shr:8 row_mask:0xf bank_mask:0xf bound_ctrl:0
    v_add_f32_dpp v93, v93, v93 row_shr:8 row_mask:0xf bank_mask:0xf bound_ctrl:0
    v_add_f32_dpp v94, v94, v94 row_shr:8 row_mask:0xf bank_mask:0xf bound_ctrl:0
    v_add_f32_dpp v95, v95, v95 row_shr:8 row_mask:0xf bank_mask:0xf bound_ctrl:0
    v_add_f32_dpp v80, v80, v80 row_bcast:15 row_mask:0xa bank_mask:0xf bound_ctrl:0
    v_add_f32_dpp v81, v81, v81 row_bcast:15 row_mask:0xa bank_mask:0xf bound_ctrl:0
    v_add_f32_dpp v82, v82, v82 row_bcast:15 row_mask:0xa bank_mask:0xf bound_ctrl:0
    v_add_f32_dpp v83, v83, v83 row_bcast:15 row_mask:0xa bank_mask:0xf bound_ctrl:0
    v_add_f32_dpp v84, v84, v84 row_bcast:15 row_mask:0xa bank_mask:0xf bound_ctrl:0
    v_add_f32_dpp v85, v85, v85 row_bcast:15 row_mask:0xa bank_mask:0xf bound_ctrl:0
    v_add_f32_dpp v86, v86, v86 row_bcast:15 row_mask:0xa bank_mask:0xf bound_ctrl:0
    v_add_f32_dpp v87, v87, v87 row_bcast:15 row_mask:0xa bank_mask:0xf bound_ctrl:0
    v_add_f32_dpp v88, v88, v88 row_bcast:15 row_mask:0xa bank_mask:0xf bound_ctrl:0
    v_add_f32_dpp v89, v89, v89 row_bcast:15 row_mask:0xa bank_mask:0xf bound_ctrl:0
    v_add_f32_dpp v90, v90, v90 row_bcast:15 row_mask:0xa bank_mask:0xf bound_ctrl:0
    v_add_f32_dpp v91, v91, v91 row_bcast:15 row_mask:0xa bank_mask:0xf bound_ctrl:0
    v_add_f32_dpp v92, v92, v92 row_bcast:15 row_mask:0xa bank_mask:0xf bound_ctrl:0
    v_add_f32_dpp v93, v93, v93 row_bcast:15 row_mask:0xa bank_mask:0xf bound_ctrl:0
    v_add_f32_dpp v94, v94, v94 row_bcast:15 row_mask:0xa bank_mask:0xf bound_ctrl:0
    v_add_f32_dpp v95, v95, v95 row_bcast:15 row_mask:0xa bank_mask:0xf bound_ctrl:0
    v_add_f32_dpp v80, v80, v80 row_bcast:31 row_mask:0xc bank_mask:0xf bound_ctrl:0
    v_add_f32_dpp v81, v81, v81 row_bcast:31 row_mask:0xc bank_mask:0xf bound_ctrl:0
    v_add_f32_dpp v82, v82, v82 row_bcast:31 row_mask:0xc bank_mask:0xf bound_ctrl:0
    v_add_f32_dpp v83, v83, v83 row_bcast:31 row_mask:0xc bank_mask:0xf bound_ctrl:0
    v_add_f32_dpp v84, v84, v84 row_bcast:31 row_mask:0xc bank_mask:0xf bound_ctrl:0
    v_add_f32_dpp v85, v85, v85 row_bcast:31 row_mask:0xc bank_mask:0xf bound_ctrl:0
    v_add_f32_dpp v86, v86, v86 row_bcast:31 row_mask:0xc bank_mask:0xf bound_ctrl:0
    v_add_f32_dpp v87, v87, v87 row_bcast:31 row_mask:0xc bank_mask:0xf bound_ctrl:0
    v_add_f32_dpp v88, v88, v88 row_bcast:31 row_mask:0xc bank_mask:0xf bound_ctrl:0
    v_add_f32_dpp v89, v89, v89 row_bcast:31 row_mask:0xc bank_mask:0xf bound_ctrl:0
    v_add_f32_dpp v90, v90, v90 row_bcast:31 row_mask:0xc bank_mask:0xf bound_ctrl:0
    v_add_f32_dpp v91, v91, v91 row_bcast:31 row_mask:0xc bank_mask:0xf bound_ctrl:0
    v_add_f32_dpp v92, v92, v92 row_bcast:31 row_mask:0xc bank_mask:0xf bound_ctrl:0
    v_add_f32_dpp v93, v93, v93 row_bcast:31 row_mask:0xc bank_mask:0xf bound_ctrl:0
    v_add_f32_dpp v94, v94, v94 row_bcast:31 row_mask:0xc bank_mask:0xf bound_ctrl:0
    v_add_f32_dpp v95, v95, v95 row_bcast:31 row_mask:0xc bank_mask:0xf bound_ctrl:0
    v_lshlrev_b32 v5, 1, v3
    v_mov_b32 v8, 0
    v_mov_b32 v9, 0
    v_cmp_eq_u32 vcc, 63, v2
    s_and_saveexec_b64 s[30:31], vcc
    s_mov_b32 s23, 8388608
    s_mov_b32 s16, 0x3b000000
    s_mov_b32 s17, 0x3727c5ac
    v_mul_f32 v80, s16, v80
    v_mul_f32 v88, s16, v88
    v_fma_f32 v88, -v80, v80, v88
    v_max_f32 v88, 0, v88
    v_cvt_pk_bf16_f32 v80, v80, v80
    v_lshlrev_b32 v80, 16, v80
    v_cvt_pk_bf16_f32 v88, v88, v88
    v_lshlrev_b32 v88, 16, v88
    v_add_f32 v88, s17, v88
    v_cvt_pk_bf16_f32 v88, v88, v88
    v_lshlrev_b32 v88, 16, v88
    v_sqrt_f32 v88, v88
    s_nop 0
    v_cvt_pk_bf16_f32 v88, v88, v88
    v_lshlrev_b32 v88, 16, v88
    v_rcp_f32 v88, v88
    v_mul_f32 v81, s16, v81
    v_mul_f32 v89, s16, v89
    v_fma_f32 v89, -v81, v81, v89
    v_max_f32 v89, 0, v89
    v_cvt_pk_bf16_f32 v81, v81, v81
    v_lshlrev_b32 v81, 16, v81
    v_cvt_pk_bf16_f32 v89, v89, v89
    v_lshlrev_b32 v89, 16, v89
    v_add_f32 v89, s17, v89
    v_cvt_pk_bf16_f32 v89, v89, v89
    v_lshlrev_b32 v89, 16, v89
    v_sqrt_f32 v89, v89
    s_nop 0
    v_cvt_pk_bf16_f32 v89, v89, v89
    v_lshlrev_b32 v89, 16, v89
    v_rcp_f32 v89, v89
    v_mul_f32 v82, s16, v82
    v_mul_f32 v90, s16, v90
    v_fma_f32 v90, -v82, v82, v90
    v_max_f32 v90, 0, v90
    v_cvt_pk_bf16_f32 v82, v82, v82
    v_lshlrev_b32 v82, 16, v82
    v_cvt_pk_bf16_f32 v90, v90, v90
    v_lshlrev_b32 v90, 16, v90
    v_add_f32 v90, s17, v90
    v_cvt_pk_bf16_f32 v90, v90, v90
    v_lshlrev_b32 v90, 16, v90
    v_sqrt_f32 v90, v90
    s_nop 0
    v_cvt_pk_bf16_f32 v90, v90, v90
    v_lshlrev_b32 v90, 16, v90
    v_rcp_f32 v90, v90
    v_mul_f32 v83, s16, v83
    v_mul_f32 v91, s16, v91
    v_fma_f32 v91, -v83, v83, v91
    v_max_f32 v91, 0, v91
    v_cvt_pk_bf16_f32 v83, v83, v83
    v_lshlrev_b32 v83, 16, v83
    v_cvt_pk_bf16_f32 v91, v91, v91
    v_lshlrev_b32 v91, 16, v91
    v_add_f32 v91, s17, v91
    v_cvt_pk_bf16_f32 v91, v91, v91
    v_lshlrev_b32 v91, 16, v91
    v_sqrt_f32 v91, v91
    s_nop 0
    v_cvt_pk_bf16_f32 v91, v91, v91
    v_lshlrev_b32 v91, 16, v91
    v_rcp_f32 v91, v91
    v_mul_f32 v84, s16, v84
    v_mul_f32 v92, s16, v92
    v_fma_f32 v92, -v84, v84, v92
    v_max_f32 v92, 0, v92
    v_cvt_pk_bf16_f32 v84, v84, v84
    v_lshlrev_b32 v84, 16, v84
    v_cvt_pk_bf16_f32 v92, v92, v92
    v_lshlrev_b32 v92, 16, v92
    v_add_f32 v92, s17, v92
    v_cvt_pk_bf16_f32 v92, v92, v92
    v_lshlrev_b32 v92, 16, v92
    v_sqrt_f32 v92, v92
    s_nop 0
    v_cvt_pk_bf16_f32 v92, v92, v92
    v_lshlrev_b32 v92, 16, v92
    v_rcp_f32 v92, v92
    v_mul_f32 v85, s16, v85
    v_mul_f32 v93, s16, v93
    v_fma_f32 v93, -v85, v85, v93
    v_max_f32 v93, 0, v93
    v_cvt_pk_bf16_f32 v85, v85, v85
    v_lshlrev_b32 v85, 16, v85
    v_cvt_pk_bf16_f32 v93, v93, v93
    v_lshlrev_b32 v93, 16, v93
    v_add_f32 v93, s17, v93
    v_cvt_pk_bf16_f32 v93, v93, v93
    v_lshlrev_b32 v93, 16, v93
    v_sqrt_f32 v93, v93
    s_nop 0
    v_cvt_pk_bf16_f32 v93, v93, v93
    v_lshlrev_b32 v93, 16, v93
    v_rcp_f32 v93, v93
    v_mul_f32 v86, s16, v86
    v_mul_f32 v94, s16, v94
    v_fma_f32 v94, -v86, v86, v94
    v_max_f32 v94, 0, v94
    v_cvt_pk_bf16_f32 v86, v86, v86
    v_lshlrev_b32 v86, 16, v86
    v_cvt_pk_bf16_f32 v94, v94, v94
    v_lshlrev_b32 v94, 16, v94
    v_add_f32 v94, s17, v94
    v_cvt_pk_bf16_f32 v94, v94, v94
    v_lshlrev_b32 v94, 16, v94
    v_sqrt_f32 v94, v94
    s_nop 0
    v_cvt_pk_bf16_f32 v94, v94, v94
    v_lshlrev_b32 v94, 16, v94
    v_rcp_f32 v94, v94
    v_mul_f32 v87, s16, v87
    v_mul_f32 v95, s16, v95
    v_fma_f32 v95, -v87, v87, v95
    v_max_f32 v95, 0, v95
    v_cvt_pk_bf16_f32 v87, v87, v87
    v_lshlrev_b32 v87, 16, v87
    v_cvt_pk_bf16_f32 v95, v95, v95
    v_lshlrev_b32 v95, 16, v95
    v_add_f32 v95, s17, v95
    v_cvt_pk_bf16_f32 v95, v95, v95
    v_lshlrev_b32 v95, 16, v95
    v_sqrt_f32 v95, v95
    s_nop 0
    v_cvt_pk_bf16_f32 v95, v95, v95
    v_lshlrev_b32 v95, 16, v95
    v_rcp_f32 v95, v95
    s_nop 0
    v_mov_b32 v6, v80
    v_mov_b32 v7, v88
    buffer_store_dwordx2 v[6:7], v5, s[8:11], s23 offen offset:0
    s_nop 1
    v_mov_b32 v6, v81
    v_mov_b32 v7, v89
    buffer_store_dwordx2 v[6:7], v5, s[8:11], s23 offen offset:8
    s_nop 1
    v_add_u32 v5, 4096, v5
    v_mov_b32 v6, v82
    v_mov_b32 v7, v90
    buffer_store_dwordx2 v[6:7], v5, s[8:11], s23 offen offset:0
    s_nop 1
    v_mov_b32 v6, v83
    v_mov_b32 v7, v91
    buffer_store_dwordx2 v[6:7], v5, s[8:11], s23 offen offset:8
    s_nop 1
    v_add_u32 v5, 4096, v5
    v_mov_b32 v6, v84
    v_mov_b32 v7, v92
    buffer_store_dwordx2 v[6:7], v5, s[8:11], s23 offen offset:0
    s_nop 1
    v_mov_b32 v6, v85
    v_mov_b32 v7, v93
    buffer_store_dwordx2 v[6:7], v5, s[8:11], s23 offen offset:8
    s_nop 1
    v_add_u32 v5, 4096, v5
    v_mov_b32 v6, v86
    v_mov_b32 v7, v94
    buffer_store_dwordx2 v[6:7], v5, s[8:11], s23 offen offset:0
    s_nop 1
    v_mov_b32 v6, v87
    v_mov_b32 v7, v95
    buffer_store_dwordx2 v[6:7], v5, s[8:11], s23 offen offset:8
    s_nop 1
    v_add_u32 v5, 4096, v5
    s_branch L_prep_end
L_kgen:
    s_load_dwordx2 s[32:33], s[0:1], 8
    s_mov_b32 s34, 131072
    s_mov_b32 s35, 0x00020000
    s_load_dwordx2 s[36:37], s[0:1], 16
    s_mov_b32 s38, 131072
    s_mov_b32 s39, 0x00020000
    s_load_dwordx2 s[40:41], s[0:1], 24
    s_mov_b32 s42, 131072
    s_mov_b32 s43, 0x00020000
    s_load_dwordx2 s[44:45], s[0:1], 32
    s_mov_b32 s46, 131072
    s_mov_b32 s47, 0x00020000
    s_load_dwordx2 s[48:49], s[0:1], 40
    s_mov_b32 s50, 131072
    s_mov_b32 s51, 0x00020000
    s_load_dwordx2 s[52:53], s[0:1], 48
    s_mov_b32 s54, 131072
    s_mov_b32 s55, 0x00020000
    s_load_dwordx2 s[56:57], s[0:1], 56
    s_mov_b32 s58, 1024
    s_mov_b32 s59, 0x00020000
    s_mov_b32 s24, 0x3fb8aa3b
    s_mov_b32 s25, 0x3e22f983
    s_and_b32 s29, s2, 1
    s_andn2_b32 s30, s2, 1
    v_lshrrev_b32 v3, 1, v1
    v_add_u32 v3, s30, v3
    v_and_b32 v4, 1, v1
    v_lshl_add_u32 v5, v4, 6, v2
    v_lshl_add_u32 v6, v3, 7, v5
    v_lshlrev_b32 v6, 1, v6
    v_lshlrev_b32 v7, 1, v3
    s_waitcnt lgkmcnt(0)
    buffer_load_ushort v10, v6, s[32:35], 0 offen
    buffer_load_ushort v11, v6, s[36:39], 0 offen
    buffer_load_ushort v12, v6, s[40:43], 0 offen
    buffer_load_ushort v13, v6, s[44:47], 0 offen
    buffer_load_ushort v14, v6, s[48:51], 0 offen
    buffer_load_ushort v15, v6, s[52:55], 0 offen
    buffer_load_ushort v16, v7, s[56:59], 0 offen
    s_waitcnt vmcnt(0)
    v_lshlrev_b32 v10, 16, v10
    v_lshlrev_b32 v11, 16, v11
    v_lshlrev_b32 v12, 16, v12
    v_lshlrev_b32 v13, 16, v13
    v_lshlrev_b32 v14, 16, v14
    v_lshlrev_b32 v15, 16, v15
    v_lshlrev_b32 v16, 16, v16
    v_mul_f32 v16, s24, v16
    v_exp_f32 v16, v16
    s_nop 0
    v_cvt_pk_bf16_f32 v16, v16, v16
    v_lshlrev_b32 v16, 16, v16
    v_mul_f32 v10, v16, v10
    v_mul_f32 v11, v16, v11
    v_mul_f32 v12, v16, v12
    v_mul_f32 v13, v16, v13
    v_mul_f32 v20, v15, v13
    v_mul_f32 v21, v15, v12
    v_fma_f32 v20, v14, v12, -v20
    v_fma_f32 v18, v14, v13, v21
    v_mov_b32 v17, v20
    s_mov_b32 s26, 8704
    v_mul_lo_u32 v8, v1, s26
    v_lshl_add_u32 v9, v2, 3, v8
    v_and_b32 v22, 15, v2
    v_lshrrev_b32 v23, 4, v2
    s_mov_b32 s26, 528
    v_mul_lo_u32 v24, v22, s26
    v_lshl_add_u32 v24, v23, 4, v24
    v_add_u32 v24, v8, v24
    s_cmp_eq_u32 s29, 0
    s_mov_b32 s26, 1.0
    s_mov_b32 s31, 4.0
    s_cselect_b32 s26, s26, s31
    v_mul_f32 v20, s26, v10
    v_mul_f32 v21, s26, v11
    v_mul_f32 v20, s24, v20
    v_mul_f32 v21, s25, v21
    v_exp_f32 v20, v20
    v_fract_f32 v21, v21
    s_nop 0
    v_cos_f32 v30, v21
    v_sin_f32 v31, v21
    s_nop 0
    v_mul_f32 v30, v30, v20
    v_mul_f32 v31, v31, v20
    s_cmp_eq_u32 s29, 0
    s_mov_b32 s26, 16.0
    s_mov_b32 s31, 64.0
    s_cselect_b32 s26, s26, s31
    v_mul_f32 v20, s26, v10
    v_mul_f32 v21, s26, v11
    v_mul_f32 v20, s24, v20
    v_mul_f32 v21, s25, v21
    v_exp_f32 v20, v20
    v_fract_f32 v21, v21
    s_nop 0
    v_cos_f32 v32, v21
    v_sin_f32 v33, v21
    s_nop 0
    v_mul_f32 v32, v32, v20
    v_mul_f32 v33, v33, v20
    s_cmp_eq_u32 s29, 0
    s_mov_b32 s26, 0.0
    s_mov_b32 s31, 512.0
    s_cselect_b32 s26, s26, s31
    v_mul_f32 v20, s26, v10
    v_mul_f32 v21, s26, v11
    v_mul_f32 v20, s24, v20
    v_mul_f32 v21, s25, v21
    v_exp_f32 v20, v20
    v_fract_f32 v21, v21
    s_nop 0
    v_cos_f32 v36, v21
    v_sin_f32 v37, v21
    s_nop 0
    v_mul_f32 v36, v36, v20
    v_mul_f32 v37, v37, v20
    v_mul_f32 v20, v18, v37
    v_mul_f32 v21, v18, v36
    v_fma_f32 v20, v17, v36, -v20
    v_fma_f32 v35, v17, v37, v21
    v_mov_b32 v34, v20
    v_mov_b32 v50, 1.0
    v_mov_b32 v51, 0
    v_mov_b32 v48, v34
    v_sub_f32 v49, 0, v35
    v_sub_f32 v33, 0, v33
    v_pk_mul_f32 v[20:21], v[48:49], v[32:33] op_sel:[0,0] op_sel_hi:[0,1]
    v_pk_mul_f32 v[22:23], v[50:51], v[30:31] op_sel:[0,0] op_sel_hi:[0,1]
    v_pk_fma_f32 v[52:53], v[48:49], v[32:33], v[20:21] op_sel:[1,1,0] op_sel_hi:[1,0,1] neg_lo:[1,0,0]
    v_pk_fma_f32 v[54:55], v[50:51], v[30:31], v[22:23] op_sel:[1,1,0] op_sel_hi:[1,0,1] neg_lo:[1,0,0]
    v_pk_mul_f32 v[20:21], v[52:53], v[32:33] op_sel:[0,0] op_sel_hi:[0,1]
    v_pk_mul_f32 v[22:23], v[54:55], v[30:31] op_sel:[0,0] op_sel_hi:[0,1]
    v_pk_fma_f32 v[56:57], v[52:53], v[32:33], v[20:21] op_sel:[1,1,0] op_sel_hi:[1,0,1] neg_lo:[1,0,0]
    v_pk_fma_f32 v[58:59], v[54:55], v[30:31], v[22:23] op_sel:[1,1,0] op_sel_hi:[1,0,1] neg_lo:[1,0,0]
    v_pk_mul_f32 v[20:21], v[56:57], v[32:33] op_sel:[0,0] op_sel_hi:[0,1]
    v_pk_mul_f32 v[22:23], v[58:59], v[30:31] op_sel:[0,0] op_sel_hi:[0,1]
    v_pk_fma_f32 v[60:61], v[56:57], v[32:33], v[20:21] op_sel:[1,1,0] op_sel_hi:[1,0,1] neg_lo:[1,0,0]
    v_pk_fma_f32 v[62:63], v[58:59], v[30:31], v[22:23] op_sel:[1,1,0] op_sel_hi:[1,0,1] neg_lo:[1,0,0]
    v_pk_mul_f32 v[20:21], v[60:61], v[32:33] op_sel:[0,0] op_sel_hi:[0,1]
    v_pk_mul_f32 v[22:23], v[62:63], v[30:31] op_sel:[0,0] op_sel_hi:[0,1]
    v_pk_fma_f32 v[64:65], v[60:61], v[32:33], v[20:21] op_sel:[1,1,0] op_sel_hi:[1,0,1] neg_lo:[1,0,0]
    v_pk_fma_f32 v[66:67], v[62:63], v[30:31], v[22:23] op_sel:[1,1,0] op_sel_hi:[1,0,1] neg_lo:[1,0,0]
    v_pk_mul_f32 v[20:21], v[64:65], v[32:33] op_sel:[0,0] op_sel_hi:[0,1]
    v_pk_mul_f32 v[22:23], v[66:67], v[30:31] op_sel:[0,0] op_sel_hi:[0,1]
    v_pk_fma_f32 v[68:69], v[64:65], v[32:33], v[20:21] op_sel:[1,1,0] op_sel_hi:[1,0,1] neg_lo:[1,0,0]
    v_pk_fma_f32 v[70:71], v[66:67], v[30:31], v[22:23] op_sel:[1,1,0] op_sel_hi:[1,0,1] neg_lo:[1,0,0]
    v_pk_mul_f32 v[20:21], v[68:69], v[32:33] op_sel:[0,0] op_sel_hi:[0,1]
    v_pk_mul_f32 v[22:23], v[70:71], v[30:31] op_sel:[0,0] op_sel_hi:[0,1]
    v_pk_fma_f32 v[72:73], v[68:69], v[32:33], v[20:21] op_sel:[1,1,0] op_sel_hi:[1,0,1] neg_lo:[1,0,0]
    v_pk_fma_f32 v[74:75], v[70:71], v[30:31], v[22:23] op_sel:[1,1,0] op_sel_hi:[1,0,1] neg_lo:[1,0,0]
    v_pk_mul_f32 v[20:21], v[72:73], v[32:33] op_sel:[0,0] op_sel_hi:[0,1]
    v_pk_mul_f32 v[22:23], v[74:75], v[30:31] op_sel:[0,0] op_sel_hi:[0,1]
    v_pk_fma_f32 v[76:77], v[72:73], v[32:33], v[20:21] op_sel:[1,1,0] op_sel_hi:[1,0,1] neg_lo:[1,0,0]
    v_pk_fma_f32 v[78:79], v[74:75], v[30:31], v[22:23] op_sel:[1,1,0] op_sel_hi:[1,0,1] neg_lo:[1,0,0]
    v_pk_mul_f32 v[20:21], v[76:77], v[32:33] op_sel:[0,0] op_sel_hi:[0,1]
    v_pk_mul_f32 v[22:23], v[78:79], v[30:31] op_sel:[0,0] op_sel_hi:[0,1]
    v_pk_fma_f32 v[80:81], v[76:77], v[32:33], v[20:21] op_sel:[1,1,0] op_sel_hi:[1,0,1] neg_lo:[1,0,0]
    v_pk_fma_f32 v[82:83], v[78:79], v[30:31], v[22:23] op_sel:[1,1,0] op_sel_hi:[1,0,1] neg_lo:[1,0,0]
    v_pk_mul_f32 v[20:21], v[80:81], v[32:33] op_sel:[0,0] op_sel_hi:[0,1]
    v_pk_mul_f32 v[22:23], v[82:83], v[30:31] op_sel:[0,0] op_sel_hi:[0,1]
    v_pk_fma_f32 v[84:85], v[80:81], v[32:33], v[20:21] op_sel:[1,1,0] op_sel_hi:[1,0,1] neg_lo:[1,0,0]
    v_pk_fma_f32 v[86:87], v[82:83], v[30:31], v[22:23] op_sel:[1,1,0] op_sel_hi:[1,0,1] neg_lo:[1,0,0]
    v_pk_mul_f32 v[20:21], v[84:85], v[32:33] op_sel:[0,0] op_sel_hi:[0,1]
    v_pk_mul_f32 v[22:23], v[86:87], v[30:31] op_sel:[0,0] op_sel_hi:[0,1]
    v_pk_fma_f32 v[88:89], v[84:85], v[32:33], v[20:21] op_sel:[1,1,0] op_sel_hi:[1,0,1] neg_lo:[1,0,0]
    v_pk_fma_f32 v[90:91], v[86:87], v[30:31], v[22:23] op_sel:[1,1,0] op_sel_hi:[1,0,1] neg_lo:[1,0,0]
    v_pk_mul_f32 v[20:21], v[88:89], v[32:33] op_sel:[0,0] op_sel_hi:[0,1]
    v_pk_mul_f32 v[22:23], v[90:91], v[30:31] op_sel:[0,0] op_sel_hi:[0,1]
    v_pk_fma_f32 v[92:93], v[88:89], v[32:33], v[20:21] op_sel:[1,1,0] op_sel_hi:[1,0,1] neg_lo:[1,0,0]
    v_pk_fma_f32 v[94:95], v[90:91], v[30:31], v[22:23] op_sel:[1,1,0] op_sel_hi:[1,0,1] neg_lo:[1,0,0]
    v_pk_mul_f32 v[20:21], v[92:93], v[32:33] op_sel:[0,0] op_sel_hi:[0,1]
    v_pk_mul_f32 v[22:23], v[94:95], v[30:31] op_sel:[0,0] op_sel_hi:[0,1]
    v_pk_fma_f32 v[96:97], v[92:93], v[32:33], v[20:21] op_sel:[1,1,0] op_sel_hi:[1,0,1] neg_lo:[1,0,0]
    v_pk_fma_f32 v[98:99], v[94:95], v[30:31], v[22:23] op_sel:[1,1,0] op_sel_hi:[1,0,1] neg_lo:[1,0,0]
    v_pk_mul_f32 v[20:21], v[96:97], v[32:33] op_sel:[0,0] op_sel_hi:[0,1]
    v_pk_mul_f32 v[22:23], v[98:99], v[30:31] op_sel:[0,0] op_sel_hi:[0,1]
    v_pk_fma_f32 v[100:101], v[96:97], v[32:33], v[20:21] op_sel:[1,1,0] op_sel_hi:[1,0,1] neg_lo:[1,0,0]
    v_pk_fma_f32 v[102:103], v[98:99], v[30:31], v[22:23] op_sel:[1,1,0] op_sel_hi:[1,0,1] neg_lo:[1,0,0]
    v_pk_mul_f32 v[20:21], v[100:101], v[32:33] op_sel:[0,0] op_sel_hi:[0,1]
    v_pk_mul_f32 v[22:23], v[102:103], v[30:31] op_sel:[0,0] op_sel_hi:[0,1]
    v_pk_fma_f32 v[104:105], v[100:101], v[32:33], v[20:21] op_sel:[1,1,0] op_sel_hi:[1,0,1] neg_lo:[1,0,0]
    v_pk_fma_f32 v[106:107], v[102:103], v[30:31], v[22:23] op_sel:[1,1,0] op_sel_hi:[1,0,1] neg_lo:[1,0,0]
    v_pk_mul_f32 v[20:21], v[104:105], v[32:33] op_sel:[0,0] op_sel_hi:[0,1]
    v_pk_mul_f32 v[22:23], v[106:107], v[30:31] op_sel:[0,0] op_sel_hi:[0,1]
    v_pk_fma_f32 v[108:109], v[104:105], v[32:33], v[20:21] op_sel:[1,1,0] op_sel_hi:[1,0,1] neg_lo:[1,0,0]
    v_pk_fma_f32 v[110:111], v[106:107], v[30:31], v[22:23] op_sel:[1,1,0] op_sel_hi:[1,0,1] neg_lo:[1,0,0]
    v_mov_b32 v144, 0
    v_mov_b32 v145, 0
    v_mov_b32 v146, 0
    v_mov_b32 v147, 0
    ds_write_b64 v9, v[48:49] offset:0
    ds_write_b64 v9, v[52:53] offset:528
    ds_write_b64 v9, v[56:57] offset:1056
    ds_write_b64 v9, v[60:61] offset:1584
    ds_write_b64 v9, v[64:65] offset:2112
    ds_write_b64 v9, v[68:69] offset:2640
    ds_write_b64 v9, v[72:73] offset:3168
    ds_write_b64 v9, v[76:77] offset:3696
    ds_write_b64 v9, v[80:81] offset:4224
    ds_write_b64 v9, v[84:85] offset:4752
    ds_write_b64 v9, v[88:89] offset:5280
    ds_write_b64 v9, v[92:93] offset:5808
    ds_write_b64 v9, v[96:97] offset:6336
    ds_write_b64 v9, v[100:101] offset:6864
    ds_write_b64 v9, v[104:105] offset:7392
    ds_write_b64 v9, v[108:109] offset:7920
    s_waitcnt lgkmcnt(0)
    ds_read_b128 v[112:115], v24 offset:0
    ds_read_b128 v[116:119], v24 offset:64
    ds_read_b128 v[120:123], v24 offset:128
    ds_read_b128 v[124:127], v24 offset:192
    ds_read_b128 v[128:131], v24 offset:256
    ds_read_b128 v[132:135], v24 offset:320
    ds_read_b128 v[136:139], v24 offset:384
    ds_read_b128 v[140:143], v24 offset:448
    s_waitcnt lgkmcnt(0)
    ds_write_b64 v9, v[50:51] offset:0
    ds_write_b64 v9, v[54:55] offset:528
    ds_write_b64 v9, v[58:59] offset:1056
    ds_write_b64 v9, v[62:63] offset:1584
    ds_write_b64 v9, v[66:67] offset:2112
    ds_write_b64 v9, v[70:71] offset:2640
    ds_write_b64 v9, v[74:75] offset:3168
    ds_write_b64 v9, v[78:79] offset:3696
    ds_write_b64 v9, v[82:83] offset:4224
    ds_write_b64 v9, v[86:87] offset:4752
    ds_write_b64 v9, v[90:91] offset:5280
    ds_write_b64 v9, v[94:95] offset:5808
    ds_write_b64 v9, v[98:99] offset:6336
    ds_write_b64 v9, v[102:103] offset:6864
    ds_write_b64 v9, v[106:107] offset:7392
    ds_write_b64 v9, v[110:111] offset:7920
    s_waitcnt lgkmcnt(0)
    ds_read_b128 v[48:51], v24 offset:0
    ds_read_b128 v[52:55], v24 offset:64
    ds_read_b128 v[56:59], v24 offset:128
    ds_read_b128 v[60:63], v24 offset:192
    ds_read_b128 v[64:67], v24 offset:256
    ds_read_b128 v[68:71], v24 offset:320
    ds_read_b128 v[72:75], v24 offset:384
    ds_read_b128 v[76:79], v24 offset:448
    s_waitcnt lgkmcnt(7)
    v_mfma_f32_16x16x4_f32 v[144:147], v112, v48, v[144:147]
    v_mfma_f32_16x16x4_f32 v[144:147], v113, v49, v[144:147]
    v_mfma_f32_16x16x4_f32 v[144:147], v114, v50, v[144:147]
    v_mfma_f32_16x16x4_f32 v[144:147], v115, v51, v[144:147]
    s_waitcnt lgkmcnt(6)
    v_mfma_f32_16x16x4_f32 v[144:147], v116, v52, v[144:147]
    v_mfma_f32_16x16x4_f32 v[144:147], v117, v53, v[144:147]
    v_mfma_f32_16x16x4_f32 v[144:147], v118, v54, v[144:147]
    v_mfma_f32_16x16x4_f32 v[144:147], v119, v55, v[144:147]
    s_waitcnt lgkmcnt(5)
    v_mfma_f32_16x16x4_f32 v[144:147], v120, v56, v[144:147]
    v_mfma_f32_16x16x4_f32 v[144:147], v121, v57, v[144:147]
    v_mfma_f32_16x16x4_f32 v[144:147], v122, v58, v[144:147]
    v_mfma_f32_16x16x4_f32 v[144:147], v123, v59, v[144:147]
    s_waitcnt lgkmcnt(4)
    v_mfma_f32_16x16x4_f32 v[144:147], v124, v60, v[144:147]
    v_mfma_f32_16x16x4_f32 v[144:147], v125, v61, v[144:147]
    v_mfma_f32_16x16x4_f32 v[144:147], v126, v62, v[144:147]
    v_mfma_f32_16x16x4_f32 v[144:147], v127, v63, v[144:147]
    s_waitcnt lgkmcnt(3)
    v_mfma_f32_16x16x4_f32 v[144:147], v128, v64, v[144:147]
    v_mfma_f32_16x16x4_f32 v[144:147], v129, v65, v[144:147]
    v_mfma_f32_16x16x4_f32 v[144:147], v130, v66, v[144:147]
    v_mfma_f32_16x16x4_f32 v[144:147], v131, v67, v[144:147]
    s_waitcnt lgkmcnt(2)
    v_mfma_f32_16x16x4_f32 v[144:147], v132, v68, v[144:147]
    v_mfma_f32_16x16x4_f32 v[144:147], v133, v69, v[144:147]
    v_mfma_f32_16x16x4_f32 v[144:147], v134, v70, v[144:147]
    v_mfma_f32_16x16x4_f32 v[144:147], v135, v71, v[144:147]
    s_waitcnt lgkmcnt(1)
    v_mfma_f32_16x16x4_f32 v[144:147], v136, v72, v[144:147]
    v_mfma_f32_16x16x4_f32 v[144:147], v137, v73, v[144:147]
    v_mfma_f32_16x16x4_f32 v[144:147], v138, v74, v[144:147]
    v_mfma_f32_16x16x4_f32 v[144:147], v139, v75, v[144:147]
    s_waitcnt lgkmcnt(0)
    v_mfma_f32_16x16x4_f32 v[144:147], v140, v76, v[144:147]
    v_mfma_f32_16x16x4_f32 v[144:147], v141, v77, v[144:147]
    v_mfma_f32_16x16x4_f32 v[144:147], v142, v78, v[144:147]
    v_mfma_f32_16x16x4_f32 v[144:147], v143, v79, v[144:147]
    s_cmp_eq_u32 s29, 0
    s_mov_b32 s26, 2.0
    s_mov_b32 s31, 8.0
    s_cselect_b32 s26, s26, s31
    v_mul_f32 v20, s26, v10
    v_mul_f32 v21, s26, v11
    v_mul_f32 v20, s24, v20
    v_mul_f32 v21, s25, v21
    v_exp_f32 v20, v20
    v_fract_f32 v21, v21
    s_nop 0
    v_cos_f32 v30, v21
    v_sin_f32 v31, v21
    s_nop 0
    v_mul_f32 v30, v30, v20
    v_mul_f32 v31, v31, v20
    s_cmp_eq_u32 s29, 0
    s_mov_b32 s26, 32.0
    s_mov_b32 s31, 128.0
    s_cselect_b32 s26, s26, s31
    v_mul_f32 v20, s26, v10
    v_mul_f32 v21, s26, v11
    v_mul_f32 v20, s24, v20
    v_mul_f32 v21, s25, v21
    v_exp_f32 v20, v20
    v_fract_f32 v21, v21
    s_nop 0
    v_cos_f32 v32, v21
    v_sin_f32 v33, v21
    s_nop 0
    v_mul_f32 v32, v32, v20
    v_mul_f32 v33, v33, v20
    s_cmp_eq_u32 s29, 0
    s_mov_b32 s26, 256.0
    s_mov_b32 s31, 1024.0
    s_cselect_b32 s26, s26, s31
    v_mul_f32 v20, s26, v10
    v_mul_f32 v21, s26, v11
    v_mul_f32 v20, s24, v20
    v_mul_f32 v21, s25, v21
    v_exp_f32 v20, v20
    v_fract_f32 v21, v21
    s_nop 0
    v_cos_f32 v36, v21
    v_sin_f32 v37, v21
    s_nop 0
    v_mul_f32 v36, v36, v20
    v_mul_f32 v37, v37, v20
    v_mul_f32 v20, v18, v37
    v_mul_f32 v21, v18, v36
    v_fma_f32 v20, v17, v36, -v20
    v_fma_f32 v35, v17, v37, v21
    v_mov_b32 v34, v20
    v_mov_b32 v50, 1.0
    v_mov_b32 v51, 0
    v_mov_b32 v48, v34
    v_sub_f32 v49, 0, v35
    v_sub_f32 v33, 0, v33
    v_pk_mul_f32 v[20:21], v[48:49], v[32:33] op_sel:[0,0] op_sel_hi:[0,1]
    v_pk_mul_f32 v[22:23], v[50:51], v[30:31] op_sel:[0,0] op_sel_hi:[0,1]
    v_pk_fma_f32 v[52:53], v[48:49], v[32:33], v[20:21] op_sel:[1,1,0] op_sel_hi:[1,0,1] neg_lo:[1,0,0]
    v_pk_fma_f32 v[54:55], v[50:51], v[30:31], v[22:23] op_sel:[1,1,0] op_sel_hi:[1,0,1] neg_lo:[1,0,0]
    v_pk_mul_f32 v[20:21], v[52:53], v[32:33] op_sel:[0,0] op_sel_hi:[0,1]
    v_pk_mul_f32 v[22:23], v[54:55], v[30:31] op_sel:[0,0] op_sel_hi:[0,1]
    v_pk_fma_f32 v[56:57], v[52:53], v[32:33], v[20:21] op_sel:[1,1,0] op_sel_hi:[1,0,1] neg_lo:[1,0,0]
    v_pk_fma_f32 v[58:59], v[54:55], v[30:31], v[22:23] op_sel:[1,1,0] op_sel_hi:[1,0,1] neg_lo:[1,0,0]
    v_pk_mul_f32 v[20:21], v[56:57], v[32:33] op_sel:[0,0] op_sel_hi:[0,1]
    v_pk_mul_f32 v[22:23], v[58:59], v[30:31] op_sel:[0,0] op_sel_hi:[0,1]
    v_pk_fma_f32 v[60:61], v[56:57], v[32:33], v[20:21] op_sel:[1,1,0] op_sel_hi:[1,0,1] neg_lo:[1,0,0]
    v_pk_fma_f32 v[62:63], v[58:59], v[30:31], v[22:23] op_sel:[1,1,0] op_sel_hi:[1,0,1] neg_lo:[1,0,0]
    v_pk_mul_f32 v[20:21], v[60:61], v[32:33] op_sel:[0,0] op_sel_hi:[0,1]
    v_pk_mul_f32 v[22:23], v[62:63], v[30:31] op_sel:[0,0] op_sel_hi:[0,1]
    v_pk_fma_f32 v[64:65], v[60:61], v[32:33], v[20:21] op_sel:[1,1,0] op_sel_hi:[1,0,1] neg_lo:[1,0,0]
    v_pk_fma_f32 v[66:67], v[62:63], v[30:31], v[22:23] op_sel:[1,1,0] op_sel_hi:[1,0,1] neg_lo:[1,0,0]
    v_pk_mul_f32 v[20:21], v[64:65], v[32:33] op_sel:[0,0] op_sel_hi:[0,1]
    v_pk_mul_f32 v[22:23], v[66:67], v[30:31] op_sel:[0,0] op_sel_hi:[0,1]
    v_pk_fma_f32 v[68:69], v[64:65], v[32:33], v[20:21] op_sel:[1,1,0] op_sel_hi:[1,0,1] neg_lo:[1,0,0]
    v_pk_fma_f32 v[70:71], v[66:67], v[30:31], v[22:23] op_sel:[1,1,0] op_sel_hi:[1,0,1] neg_lo:[1,0,0]
    v_pk_mul_f32 v[20:21], v[68:69], v[32:33] op_sel:[0,0] op_sel_hi:[0,1]
    v_pk_mul_f32 v[22:23], v[70:71], v[30:31] op_sel:[0,0] op_sel_hi:[0,1]
    v_pk_fma_f32 v[72:73], v[68:69], v[32:33], v[20:21] op_sel:[1,1,0] op_sel_hi:[1,0,1] neg_lo:[1,0,0]
    v_pk_fma_f32 v[74:75], v[70:71], v[30:31], v[22:23] op_sel:[1,1,0] op_sel_hi:[1,0,1] neg_lo:[1,0,0]
    v_pk_mul_f32 v[20:21], v[72:73], v[32:33] op_sel:[0,0] op_sel_hi:[0,1]
    v_pk_mul_f32 v[22:23], v[74:75], v[30:31] op_sel:[0,0] op_sel_hi:[0,1]
    v_pk_fma_f32 v[76:77], v[72:73], v[32:33], v[20:21] op_sel:[1,1,0] op_sel_hi:[1,0,1] neg_lo:[1,0,0]
    v_pk_fma_f32 v[78:79], v[74:75], v[30:31], v[22:23] op_sel:[1,1,0] op_sel_hi:[1,0,1] neg_lo:[1,0,0]
    v_pk_mul_f32 v[20:21], v[76:77], v[32:33] op_sel:[0,0] op_sel_hi:[0,1]
    v_pk_mul_f32 v[22:23], v[78:79], v[30:31] op_sel:[0,0] op_sel_hi:[0,1]
    v_pk_fma_f32 v[80:81], v[76:77], v[32:33], v[20:21] op_sel:[1,1,0] op_sel_hi:[1,0,1] neg_lo:[1,0,0]
    v_pk_fma_f32 v[82:83], v[78:79], v[30:31], v[22:23] op_sel:[1,1,0] op_sel_hi:[1,0,1] neg_lo:[1,0,0]
    v_pk_mul_f32 v[20:21], v[80:81], v[32:33] op_sel:[0,0] op_sel_hi:[0,1]
    v_pk_mul_f32 v[22:23], v[82:83], v[30:31] op_sel:[0,0] op_sel_hi:[0,1]
    v_pk_fma_f32 v[84:85], v[80:81], v[32:33], v[20:21] op_sel:[1,1,0] op_sel_hi:[1,0,1] neg_lo:[1,0,0]
    v_pk_fma_f32 v[86:87], v[82:83], v[30:31], v[22:23] op_sel:[1,1,0] op_sel_hi:[1,0,1] neg_lo:[1,0,0]
    v_pk_mul_f32 v[20:21], v[84:85], v[32:33] op_sel:[0,0] op_sel_hi:[0,1]
    v_pk_mul_f32 v[22:23], v[86:87], v[30:31] op_sel:[0,0] op_sel_hi:[0,1]
    v_pk_fma_f32 v[88:89], v[84:85], v[32:33], v[20:21] op_sel:[1,1,0] op_sel_hi:[1,0,1] neg_lo:[1,0,0]
    v_pk_fma_f32 v[90:91], v[86:87], v[30:31], v[22:23] op_sel:[1,1,0] op_sel_hi:[1,0,1] neg_lo:[1,0,0]
    v_pk_mul_f32 v[20:21], v[88:89], v[32:33] op_sel:[0,0] op_sel_hi:[0,1]
    v_pk_mul_f32 v[22:23], v[90:91], v[30:31] op_sel:[0,0] op_sel_hi:[0,1]
    v_pk_fma_f32 v[92:93], v[88:89], v[32:33], v[20:21] op_sel:[1,1,0] op_sel_hi:[1,0,1] neg_lo:[1,0,0]
    v_pk_fma_f32 v[94:95], v[90:91], v[30:31], v[22:23] op_sel:[1,1,0] op_sel_hi:[1,0,1] neg_lo:[1,0,0]
    v_pk_mul_f32 v[20:21], v[92:93], v[32:33] op_sel:[0,0] op_sel_hi:[0,1]
    v_pk_mul_f32 v[22:23], v[94:95], v[30:31] op_sel:[0,0] op_sel_hi:[0,1]
    v_pk_fma_f32 v[96:97], v[92:93], v[32:33], v[20:21] op_sel:[1,1,0] op_sel_hi:[1,0,1] neg_lo:[1,0,0]
    v_pk_fma_f32 v[98:99], v[94:95], v[30:31], v[22:23] op_sel:[1,1,0] op_sel_hi:[1,0,1] neg_lo:[1,0,0]
    v_pk_mul_f32 v[20:21], v[96:97], v[32:33] op_sel:[0,0] op_sel_hi:[0,1]
    v_pk_mul_f32 v[22:23], v[98:99], v[30:31] op_sel:[0,0] op_sel_hi:[0,1]
    v_pk_fma_f32 v[100:101], v[96:97], v[32:33], v[20:21] op_sel:[1,1,0] op_sel_hi:[1,0,1] neg_lo:[1,0,0]
    v_pk_fma_f32 v[102:103], v[98:99], v[30:31], v[22:23] op_sel:[1,1,0] op_sel_hi:[1,0,1] neg_lo:[1,0,0]
    v_pk_mul_f32 v[20:21], v[100:101], v[32:33] op_sel:[0,0] op_sel_hi:[0,1]
    v_pk_mul_f32 v[22:23], v[102:103], v[30:31] op_sel:[0,0] op_sel_hi:[0,1]
    v_pk_fma_f32 v[104:105], v[100:101], v[32:33], v[20:21] op_sel:[1,1,0] op_sel_hi:[1,0,1] neg_lo:[1,0,0]
    v_pk_fma_f32 v[106:107], v[102:103], v[30:31], v[22:23] op_sel:[1,1,0] op_sel_hi:[1,0,1] neg_lo:[1,0,0]
    v_pk_mul_f32 v[20:21], v[104:105], v[32:33] op_sel:[0,0] op_sel_hi:[0,1]
    v_pk_mul_f32 v[22:23], v[106:107], v[30:31] op_sel:[0,0] op_sel_hi:[0,1]
    v_pk_fma_f32 v[108:109], v[104:105], v[32:33], v[20:21] op_sel:[1,1,0] op_sel_hi:[1,0,1] neg_lo:[1,0,0]
    v_pk_fma_f32 v[110:111], v[106:107], v[30:31], v[22:23] op_sel:[1,1,0] op_sel_hi:[1,0,1] neg_lo:[1,0,0]
    v_mov_b32 v148, 0
    v_mov_b32 v149, 0
    v_mov_b32 v150, 0
    v_mov_b32 v151, 0
    ds_write_b64 v9, v[48:49] offset:0
    ds_write_b64 v9, v[52:53] offset:528
    ds_write_b64 v9, v[56:57] offset:1056
    ds_write_b64 v9, v[60:61] offset:1584
    ds_write_b64 v9, v[64:65] offset:2112
    ds_write_b64 v9, v[68:69] offset:2640
    ds_write_b64 v9, v[72:73] offset:3168
    ds_write_b64 v9, v[76:77] offset:3696
    ds_write_b64 v9, v[80:81] offset:4224
    ds_write_b64 v9, v[84:85] offset:4752
    ds_write_b64 v9, v[88:89] offset:5280
    ds_write_b64 v9, v[92:93] offset:5808
    ds_write_b64 v9, v[96:97] offset:6336
    ds_write_b64 v9, v[100:101] offset:6864
    ds_write_b64 v9, v[104:105] offset:7392
    ds_write_b64 v9, v[108:109] offset:7920
    s_waitcnt lgkmcnt(0)
    ds_read_b128 v[112:115], v24 offset:0
    ds_read_b128 v[116:119], v24 offset:64
    ds_read_b128 v[120:123], v24 offset:128
    ds_read_b128 v[124:127], v24 offset:192
    ds_read_b128 v[128:131], v24 offset:256
    ds_read_b128 v[132:135], v24 offset:320
    ds_read_b128 v[136:139], v24 offset:384
    ds_read_b128 v[140:143], v24 offset:448
    s_waitcnt lgkmcnt(0)
    ds_write_b64 v9, v[50:51] offset:0
    ds_write_b64 v9, v[54:55] offset:528
    ds_write_b64 v9, v[58:59] offset:1056
    ds_write_b64 v9, v[62:63] offset:1584
    ds_write_b64 v9, v[66:67] offset:2112
    ds_write_b64 v9, v[70:71] offset:2640
    ds_write_b64 v9, v[74:75] offset:3168
    ds_write_b64 v9, v[78:79] offset:3696
    ds_write_b64 v9, v[82:83] offset:4224
    ds_write_b64 v9, v[86:87] offset:4752
    ds_write_b64 v9, v[90:91] offset:5280
    ds_write_b64 v9, v[94:95] offset:5808
    ds_write_b64 v9, v[98:99] offset:6336
    ds_write_b64 v9, v[102:103] offset:6864
    ds_write_b64 v9, v[106:107] offset:7392
    ds_write_b64 v9, v[110:111] offset:7920
    s_waitcnt lgkmcnt(0)
    ds_read_b128 v[48:51], v24 offset:0
    ds_read_b128 v[52:55], v24 offset:64
    ds_read_b128 v[56:59], v24 offset:128
    ds_read_b128 v[60:63], v24 offset:192
    ds_read_b128 v[64:67], v24 offset:256
    ds_read_b128 v[68:71], v24 offset:320
    ds_read_b128 v[72:75], v24 offset:384
    ds_read_b128 v[76:79], v24 offset:448
    s_waitcnt lgkmcnt(7)
    v_mfma_f32_16x16x4_f32 v[148:151], v112, v48, v[148:151]
    v_mfma_f32_16x16x4_f32 v[148:151], v113, v49, v[148:151]
    v_mfma_f32_16x16x4_f32 v[148:151], v114, v50, v[148:151]
    v_mfma_f32_16x16x4_f32 v[148:151], v115, v51, v[148:151]
    s_waitcnt lgkmcnt(6)
    v_mfma_f32_16x16x4_f32 v[148:151], v116, v52, v[148:151]
    v_mfma_f32_16x16x4_f32 v[148:151], v117, v53, v[148:151]
    v_mfma_f32_16x16x4_f32 v[148:151], v118, v54, v[148:151]
    v_mfma_f32_16x16x4_f32 v[148:151], v119, v55, v[148:151]
    s_waitcnt lgkmcnt(5)
    v_mfma_f32_16x16x4_f32 v[148:151], v120, v56, v[148:151]
    v_mfma_f32_16x16x4_f32 v[148:151], v121, v57, v[148:151]
    v_mfma_f32_16x16x4_f32 v[148:151], v122, v58, v[148:151]
    v_mfma_f32_16x16x4_f32 v[148:151], v123, v59, v[148:151]
    s_waitcnt lgkmcnt(4)
    v_mfma_f32_16x16x4_f32 v[148:151], v124, v60, v[148:151]
    v_mfma_f32_16x16x4_f32 v[148:151], v125, v61, v[148:151]
    v_mfma_f32_16x16x4_f32 v[148:151], v126, v62, v[148:151]
    v_mfma_f32_16x16x4_f32 v[148:151], v127, v63, v[148:151]
    s_waitcnt lgkmcnt(3)
    v_mfma_f32_16x16x4_f32 v[148:151], v128, v64, v[148:151]
    v_mfma_f32_16x16x4_f32 v[148:151], v129, v65, v[148:151]
    v_mfma_f32_16x16x4_f32 v[148:151], v130, v66, v[148:151]
    v_mfma_f32_16x16x4_f32 v[148:151], v131, v67, v[148:151]
    s_waitcnt lgkmcnt(2)
    v_mfma_f32_16x16x4_f32 v[148:151], v132, v68, v[148:151]
    v_mfma_f32_16x16x4_f32 v[148:151], v133, v69, v[148:151]
    v_mfma_f32_16x16x4_f32 v[148:151], v134, v70, v[148:151]
    v_mfma_f32_16x16x4_f32 v[148:151], v135, v71, v[148:151]
    s_waitcnt lgkmcnt(1)
    v_mfma_f32_16x16x4_f32 v[148:151], v136, v72, v[148:151]
    v_mfma_f32_16x16x4_f32 v[148:151], v137, v73, v[148:151]
    v_mfma_f32_16x16x4_f32 v[148:151], v138, v74, v[148:151]
    v_mfma_f32_16x16x4_f32 v[148:151], v139, v75, v[148:151]
    s_waitcnt lgkmcnt(0)
    v_mfma_f32_16x16x4_f32 v[148:151], v140, v76, v[148:151]
    v_mfma_f32_16x16x4_f32 v[148:151], v141, v77, v[148:151]
    v_mfma_f32_16x16x4_f32 v[148:151], v142, v78, v[148:151]
    v_mfma_f32_16x16x4_f32 v[148:151], v143, v79, v[148:151]
    s_nop 7
    s_nop 3
    v_and_b32 v22, 15, v2
    v_lshrrev_b32 v23, 4, v2
    v_lshlrev_b32 v25, 8, v23
    v_lshl_add_u32 v25, v22, 2, v25
    v_add_u32 v25, v8, v25
    ds_write_b32 v25, v144 offset:0
    ds_write_b32 v25, v145 offset:64
    ds_write_b32 v25, v146 offset:128
    ds_write_b32 v25, v147 offset:192
    ds_write_b32 v25, v148 offset:1024
    ds_write_b32 v25, v149 offset:1088
    ds_write_b32 v25, v150 offset:1152
    ds_write_b32 v25, v151 offset:1216
    s_waitcnt lgkmcnt(0)
    s_barrier
    v_and_b32 v26, 2, v1
    s_mov_b32 s26, 8704
    v_mul_lo_u32 v26, v26, s26
    s_mov_b32 s27, 0x7fff
    s_mov_b32 s28, 128
    s_lshl_b32 s30, s29, 1
    s_add_u32 s31, s30, 1
    s_cmp_eq_u32 s29, 0
    s_cselect_b32 s22, 63, 127
    s_lshl_b32 s23, s29, 6
    v_and_b32 v30, s22, v5
    v_add_u32 v30, s23, v30
    v_lshlrev_b32 v27, 3, v30
    v_or_b32 v27, 128, v27
    v_ffbh_u32 v27, v27
    v_sub_u32 v28, 24, v27
    v_subrev_u32 v29, s30, v28
    v_lshl_add_u32 v29, v29, 10, v26
    v_min_u32 v27, 1, v28
    v_lshlrev_b32 v27, 9, v27
    v_sub_u32 v29, v29, v27
    v_lshlrev_b32 v31, v28, 1
    v_add_u32 v31, -1, v31
    v_add_u32 v28, 1, v28
    v_lshlrev_b32 v32, 4, v30
    v_add_u32 v27, 0, v32
    v_bfe_u32 v33, v27, v28, 1
    v_add3_u32 v27, v27, v31, v33
    v_lshrrev_b32 v27, v28, v27
    v_lshl_add_u32 v27, v27, 2, v29
    ds_read_b32 v40, v27
    ds_read_b32 v56, v27 offset:8704
    v_add_u32 v27, 2, v32
    v_bfe_u32 v33, v27, v28, 1
    v_add3_u32 v27, v27, v31, v33
    v_lshrrev_b32 v27, v28, v27
    v_lshl_add_u32 v27, v27, 2, v29
    ds_read_b32 v41, v27
    ds_read_b32 v57, v27 offset:8704
    v_add_u32 v27, 4, v32
    v_bfe_u32 v33, v27, v28, 1
    v_add3_u32 v27, v27, v31, v33
    v_lshrrev_b32 v27, v28, v27
    v_lshl_add_u32 v27, v27, 2, v29
    ds_read_b32 v42, v27
    ds_read_b32 v58, v27 offset:8704
    v_add_u32 v27, 6, v32
    v_bfe_u32 v33, v27, v28, 1
    v_add3_u32 v27, v27, v31, v33
    v_lshrrev_b32 v27, v28, v27
    v_lshl_add_u32 v27, v27, 2, v29
    ds_read_b32 v43, v27
    ds_read_b32 v59, v27 offset:8704
    v_add_u32 v27, 8, v32
    v_bfe_u32 v33, v27, v28, 1
    v_add3_u32 v27, v27, v31, v33
    v_lshrrev_b32 v27, v28, v27
    v_lshl_add_u32 v27, v27, 2, v29
    ds_read_b32 v44, v27
    ds_read_b32 v60, v27 offset:8704
    v_add_u32 v27, 10, v32
    v_bfe_u32 v33, v27, v28, 1
    v_add3_u32 v27, v27, v31, v33
    v_lshrrev_b32 v27, v28, v27
    v_lshl_add_u32 v27, v27, 2, v29
    ds_read_b32 v45, v27
    ds_read_b32 v61, v27 offset:8704
    v_add_u32 v27, 12, v32
    v_bfe_u32 v33, v27, v28, 1
    v_add3_u32 v27, v27, v31, v33
    v_lshrrev_b32 v27, v28, v27
    v_lshl_add_u32 v27, v27, 2, v29
    ds_read_b32 v46, v27
    ds_read_b32 v62, v27 offset:8704
    v_add_u32 v27, 14, v32
    v_bfe_u32 v33, v27, v28, 1
    v_add3_u32 v27, v27, v31, v33
    v_lshrrev_b32 v27, v28, v27
    v_lshl_add_u32 v27, v27, 2, v29
    ds_read_b32 v47, v27
    ds_read_b32 v63, v27 offset:8704
    s_waitcnt lgkmcnt(0)
    v_add_f32 v40, v40, v56
    v_add_f32 v41, v41, v57
    v_add_f32 v42, v42, v58
    v_add_f32 v43, v43, v59
    v_add_f32 v44, v44, v60
    v_add_f32 v45, v45, v61
    v_add_f32 v46, v46, v62
    v_add_f32 v47, v47, v63
    v_cvt_pk_bf16_f32 v72, v47, v46
    v_cvt_pk_bf16_f32 v73, v45, v44
    v_cvt_pk_bf16_f32 v74, v43, v42
    v_cvt_pk_bf16_f32 v75, v41, v40
    v_lshlrev_b32 v27, 13, v3
    v_lshl_add_u32 v27, v30, 4, v27
    s_mov_b32 s23, 9437184
    buffer_store_dwordx4 v[72:75], v27, s[8:11], s23 offen
    s_nop 1
    s_cmp_eq_u32 s29, 0
    s_cbranch_scc1 L_prep_end
    v_and_b32 v30, 63, v5
    v_add_u32 v30, 192, v30
    v_lshlrev_b32 v27, 3, v30
    v_or_b32 v27, 128, v27
    v_ffbh_u32 v27, v27
    v_sub_u32 v28, 24, v27
    v_subrev_u32 v29, s30, v28
    v_lshl_add_u32 v29, v29, 10, v26
    v_min_u32 v27, 1, v28
    v_lshlrev_b32 v27, 9, v27
    v_sub_u32 v29, v29, v27
    v_lshlrev_b32 v31, v28, 1
    v_add_u32 v31, -1, v31
    v_add_u32 v28, 1, v28
    v_lshlrev_b32 v32, 4, v30
    v_add_u32 v27, 0, v32
    v_bfe_u32 v33, v27, v28, 1
    v_add3_u32 v27, v27, v31, v33
    v_lshrrev_b32 v27, v28, v27
    v_lshl_add_u32 v27, v27, 2, v29
    ds_read_b32 v40, v27
    ds_read_b32 v56, v27 offset:8704
    v_add_u32 v27, 2, v32
    v_bfe_u32 v33, v27, v28, 1
    v_add3_u32 v27, v27, v31, v33
    v_lshrrev_b32 v27, v28, v27
    v_lshl_add_u32 v27, v27, 2, v29
    ds_read_b32 v41, v27
    ds_read_b32 v57, v27 offset:8704
    v_add_u32 v27, 4, v32
    v_bfe_u32 v33, v27, v28, 1
    v_add3_u32 v27, v27, v31, v33
    v_lshrrev_b32 v27, v28, v27
    v_lshl_add_u32 v27, v27, 2, v29
    ds_read_b32 v42, v27
    ds_read_b32 v58, v27 offset:8704
    v_add_u32 v27, 6, v32
    v_bfe_u32 v33, v27, v28, 1
    v_add3_u32 v27, v27, v31, v33
    v_lshrrev_b32 v27, v28, v27
    v_lshl_add_u32 v27, v27, 2, v29
    ds_read_b32 v43, v27
    ds_read_b32 v59, v27 offset:8704
    v_add_u32 v27, 8, v32
    v_bfe_u32 v33, v27, v28, 1
    v_add3_u32 v27, v27, v31, v33
    v_lshrrev_b32 v27, v28, v27
    v_lshl_add_u32 v27, v27, 2, v29
    ds_read_b32 v44, v27
    ds_read_b32 v60, v27 offset:8704
    v_add_u32 v27, 10, v32
    v_bfe_u32 v33, v27, v28, 1
    v_add3_u32 v27, v27, v31, v33
    v_lshrrev_b32 v27, v28, v27
    v_lshl_add_u32 v27, v27, 2, v29
    ds_read_b32 v45, v27
    ds_read_b32 v61, v27 offset:8704
    v_add_u32 v27, 12, v32
    v_bfe_u32 v33, v27, v28, 1
    v_add3_u32 v27, v27, v31, v33
    v_lshrrev_b32 v27, v28, v27
    v_lshl_add_u32 v27, v27, 2, v29
    ds_read_b32 v46, v27
    ds_read_b32 v62, v27 offset:8704
    v_add_u32 v27, 14, v32
    v_bfe_u32 v33, v27, v28, 1
    v_add3_u32 v27, v27, v31, v33
    v_lshrrev_b32 v27, v28, v27
    v_lshl_add_u32 v27, v27, 2, v29
    ds_read_b32 v47, v27
    ds_read_b32 v63, v27 offset:8704
    s_waitcnt lgkmcnt(0)
    v_add_f32 v40, v40, v56
    v_add_f32 v41, v41, v57
    v_add_f32 v42, v42, v58
    v_add_f32 v43, v43, v59
    v_add_f32 v44, v44, v60
    v_add_f32 v45, v45, v61
    v_add_f32 v46, v46, v62
    v_add_f32 v47, v47, v63
    v_cvt_pk_bf16_f32 v72, v47, v46
    v_cvt_pk_bf16_f32 v73, v45, v44
    v_cvt_pk_bf16_f32 v74, v43, v42
    v_cvt_pk_bf16_f32 v75, v41, v40
    v_lshlrev_b32 v27, 13, v3
    v_lshl_add_u32 v27, v30, 4, v27
    s_mov_b32 s23, 9437184
    buffer_store_dwordx4 v[72:75], v27, s[8:11], s23 offen
    s_nop 1
L_prep_end:
L_pe2:
    s_endpgm
.section .rodata,"a"
.p2align 6
.amdhsa_kernel prep_kernel
  .amdhsa_next_free_vgpr 160
  .amdhsa_next_free_sgpr 96
  .amdhsa_accum_offset 160
  .amdhsa_group_segment_fixed_size 0
  .amdhsa_kernarg_size 120
  .amdhsa_user_sgpr_count 2
  .amdhsa_user_sgpr_kernarg_segment_ptr 1
  .amdhsa_system_sgpr_workgroup_id_x 1
.end_amdhsa_kernel
.text

.globl conv1_kernel
.p2align 8
.type conv1_kernel,@function
conv1_kernel:
    s_cmp_ge_u32 s2, 512
    s_cbranch_scc1 L_end_conv1_kernel
    s_load_dwordx2 s[8:9], s[0:1], 112
    s_mov_b32 s10, 25165824
    s_mov_b32 s11, 0x00020000
    s_load_dwordx2 s[12:13], s[0:1], 64
    s_mov_b32 s14, 1024
    s_mov_b32 s15, 0x00020000
    v_lshrrev_b32 v1, 6, v0
    v_and_b32 v2, 63, v0
    s_lshl_b32 s3, s2, 13
    s_add_u32 s3, s3, 9437184
    s_lshl_b32 s4, s2, 12
    s_add_u32 s5, s4, 2097152
    s_add_u32 s4, s4, 0
    s_lshl_b32 s6, s2, 1
    s_mov_b32 s7, 8388608
    s_waitcnt lgkmcnt(0)
    v_lshlrev_b32 v3, 4, v0
    buffer_load_dwordx4 v[16:19], v3, s[8:11], s3 offen
    buffer_load_dwordx4 v[32:35], v3, s[8:11], s4 offen
    v_mov_b32 v5, s6
    buffer_load_ushort v6, v5, s[12:15], 0 offen
    s_add_u32 s20, s7, 0
    buffer_load_dwordx4 v[40:43], v3, s[8:11], s20 offen
    s_add_u32 s21, s7, 4096
    buffer_load_dwordx4 v[44:47], v3, s[8:11], s21 offen
    s_add_u32 s22, s7, 8192
    buffer_load_dwordx4 v[48:51], v3, s[8:11], s22 offen
    s_add_u32 s23, s7, 12288
    buffer_load_dwordx4 v[52:55], v3, s[8:11], s23 offen
    v_mov_b32 v8, 0
    v_mov_b32 v9, 0
    v_mov_b32 v10, 0
    v_mov_b32 v11, 0
    v_mov_b32 v12, 33280
    v_min_u32 v13, 0x9f, v0
    v_lshl_add_u32 v13, v13, 4, v12
    ds_write_b128 v13, v[8:11]
    v_lshrrev_b32 v14, 2, v2
    v_and_b32 v14, 7, v14
    s_mov_b32 s16, 4160
    v_mul_lo_u32 v14, v14, s16
    v_and_b32 v15, 3, v2
    v_lshl_add_u32 v14, v15, 4, v14
    ds_write_b128 v14, v[8:11]
    v_lshrrev_b32 v14, 2, v0
    s_mov_b32 s16, 80
    v_mul_lo_u32 v14, v14, s16
    v_lshl_add_u32 v14, v15, 4, v14
    v_add_u32 v14, v12, v14
    s_waitcnt vmcnt(6)
    ds_write_b128 v14, v[16:19] offset:2560
    s_waitcnt vmcnt(0)
    v_lshlrev_b32 v6, 16, v6
    s_mov_b32 s16, 0x3b000000
    s_mov_b32 s17, 0x3727c5ac
    v_lshlrev_b32 v104, 16, v32
    v_sub_f32 v40, v104, v40
    v_cvt_pk_bf16_f32 v40, v40, v40
    v_lshlrev_b32 v40, 16, v40
    v_mul_f32 v40, v40, v41
    v_cvt_pk_bf16_f32 v40, v40, v40
    v_lshlrev_b32 v40, 16, v40
    v_mul_f32 v120, v40, v6
    v_cvt_pk_bf16_f32 v120, v120, v120
    v_lshlrev_b32 v120, 16, v120
    v_and_b32 v105, 0xffff0000, v32
    v_sub_f32 v42, v105, v42
    v_cvt_pk_bf16_f32 v42, v42, v42
    v_lshlrev_b32 v42, 16, v42
    v_mul_f32 v42, v42, v43
    v_cvt_pk_bf16_f32 v42, v42, v42
    v_lshlrev_b32 v42, 16, v42
    v_mul_f32 v121, v42, v6
    v_cvt_pk_bf16_f32 v121, v121, v121
    v_lshlrev_b32 v121, 16, v121
    v_cvt_pk_bf16_f32 v20, v40, v42
    v_lshlrev_b32 v106, 16, v33
    v_sub_f32 v44, v106, v44
    v_cvt_pk_bf16_f32 v44, v44, v44
    v_lshlrev_b32 v44, 16, v44
    v_mul_f32 v44, v44, v45
    v_cvt_pk_bf16_f32 v44, v44, v44
    v_lshlrev_b32 v44, 16, v44
    v_mul_f32 v122, v44, v6
    v_cvt_pk_bf16_f32 v122, v122, v122
    v_lshlrev_b32 v122, 16, v122
    v_and_b32 v107, 0xffff0000, v33
    v_sub_f32 v46, v107, v46
    v_cvt_pk_bf16_f32 v46, v46, v46
    v_lshlrev_b32 v46, 16, v46
    v_mul_f32 v46, v46, v47
    v_cvt_pk_bf16_f32 v46, v46, v46
    v_lshlrev_b32 v46, 16, v46
    v_mul_f32 v123, v46, v6
    v_cvt_pk_bf16_f32 v123, v123, v123
    v_lshlrev_b32 v123, 16, v123
    v_cvt_pk_bf16_f32 v21, v44, v46
    v_lshlrev_b32 v108, 16, v34
    v_sub_f32 v48, v108, v48
    v_cvt_pk_bf16_f32 v48, v48, v48
    v_lshlrev_b32 v48, 16, v48
    v_mul_f32 v48, v48, v49
    v_cvt_pk_bf16_f32 v48, v48, v48
    v_lshlrev_b32 v48, 16, v48
    v_mul_f32 v124, v48, v6
    v_cvt_pk_bf16_f32 v124, v124, v124
    v_lshlrev_b32 v124, 16, v124
    v_and_b32 v109, 0xffff0000, v34
    v_sub_f32 v50, v109, v50
    v_cvt_pk_bf16_f32 v50, v50, v50
    v_lshlrev_b32 v50, 16, v50
    v_mul_f32 v50, v50, v51
    v_cvt_pk_bf16_f32 v50, v50, v50
    v_lshlrev_b32 v50, 16, v50
    v_mul_f32 v125, v50, v6
    v_cvt_pk_bf16_f32 v125, v125, v125
    v_lshlrev_b32 v125, 16, v125
    v_cvt_pk_bf16_f32 v22, v48, v50
    v_lshlrev_b32 v110, 16, v35
    v_sub_f32 v52, v110, v52
    v_cvt_pk_bf16_f32 v52, v52, v52
    v_lshlrev_b32 v52, 16, v52
    v_mul_f32 v52, v52, v53
    v_cvt_pk_bf16_f32 v52, v52, v52
    v_lshlrev_b32 v52, 16, v52
    v_mul_f32 v126, v52, v6
    v_cvt_pk_bf16_f32 v126, v126, v126
    v_lshlrev_b32 v126, 16, v126
    v_and_b32 v111, 0xffff0000, v35
    v_sub_f32 v54, v111, v54
    v_cvt_pk_bf16_f32 v54, v54, v54
    v_lshlrev_b32 v54, 16, v54
    v_mul_f32 v54, v54, v55
    v_cvt_pk_bf16_f32 v54, v54, v54
    v_lshlrev_b32 v54, 16, v54
    v_mul_f32 v127, v54, v6
    v_cvt_pk_bf16_f32 v127, v127, v127
    v_lshlrev_b32 v127, 16, v127
    v_cvt_pk_bf16_f32 v23, v52, v54
    ds_write_b128 v3, v[20:23] offset:48656
    v_mov_b32 v15, 0
    ds_write_b128 v15, v[8:11] offset:48640
    s_waitcnt lgkmcnt(0)
    s_barrier
    ds_read_b128 v[16:19], v3 offset:48640
    s_waitcnt lgkmcnt(0)
    v_alignbit_b32 v40, v17, v16, 16
    v_alignbit_b32 v41, v18, v17, 16
    v_alignbit_b32 v42, v19, v18, 16
    v_alignbit_b32 v43, v20, v19, 16
    v_alignbit_b32 v44, v21, v20, 16
    v_alignbit_b32 v45, v22, v21, 16
    v_alignbit_b32 v46, v23, v22, 16
    ds_write_b128 v3, v[40:43] offset:64
    v_mov_b32 v48, v17
    v_mov_b32 v49, v18
    v_mov_b32 v50, v19
    v_mov_b32 v51, v20
    ds_write_b128 v3, v[48:51] offset:4224
    v_mov_b32 v52, v41
    v_mov_b32 v53, v42
    v_mov_b32 v54, v43
    v_mov_b32 v55, v44
    ds_write_b128 v3, v[52:55] offset:8384
    ds_write_b128 v3, v[18:21] offset:12544
    ds_write_b128 v3, v[42:45] offset:16704
    v_mov_b32 v56, v19
    v_mov_b32 v57, v20
    v_mov_b32 v58, v21
    v_mov_b32 v59, v22
    ds_write_b128 v3, v[56:59] offset:20864
    v_mov_b32 v60, v43
    v_mov_b32 v61, v44
    v_mov_b32 v62, v45
    v_mov_b32 v63, v46
    ds_write_b128 v3, v[60:63] offset:25024
    ds_write_b128 v3, v[20:23] offset:29184
    v_and_b32 v3, 31, v2
    v_lshrrev_b32 v4, 5, v2
    v_and_b32 v5, 7, v3
    v_lshrrev_b32 v7, 3, v3
    s_mov_b32 s16, 4160
    v_mul_lo_u32 v5, v5, s16
    v_sub_u32 v7, v7, v4
    v_add_u32 v7, 2, v7
    v_lshl_add_u32 v5, v7, 4, v5
    v_and_b32 v14, 1, v1
    v_lshrrev_b32 v15, 1, v1
    s_mov_b32 s16, 80
    v_mul_lo_u32 v7, v3, s16
    v_lshl_add_u32 v7, v4, 4, v7
    v_add_u32 v7, v12, v7
    v_lshl_add_u32 v7, v14, 5, v7
    v_lshlrev_b32 v13, 5, v14
    v_sub_u32 v5, v5, v13
    v_lshl_add_u32 v5, v15, 10, v5
    s_movk_i32 s16, 1280
    v_mul_lo_u32 v15, v15, s16
    v_sub_u32 v7, v7, v15
    s_waitcnt lgkmcnt(0)
    s_barrier
    ds_read_b128 v[168:171], v5 offset:32
    ds_read_b128 v[176:179], v7 offset:5120
    ds_read_b128 v[172:175], v7 offset:2560
    ds_read_b128 v[180:183], v5 offset:2080
    ds_read_b128 v[184:187], v5 offset:96
    ds_read_b128 v[192:195], v7 offset:5040
    ds_read_b128 v[188:191], v7 offset:2480
    ds_read_b128 v[196:199], v5 offset:2144
    ds_read_b128 v[200:203], v5 offset:160
    ds_read_b128 v[208:211], v7 offset:4960
    ds_read_b128 v[204:207], v7 offset:2400
    ds_read_b128 v[212:215], v5 offset:2208
    s_waitcnt lgkmcnt(8)
    v_mfma_f32_32x32x16_bf16 v[152:167], v[168:171], v[176:179], 0
    v_mfma_f32_32x32x16_bf16 v[136:151], v[168:171], v[172:175], 0
    v_mfma_f32_32x32x16_bf16 v[152:167], v[180:183], v[172:175], v[152:167]
    ds_read_b128 v[168:171], v5 offset:224
    ds_read_b128 v[176:179], v7 offset:4880
    ds_read_b128 v[172:175], v7 offset:2320
    ds_read_b128 v[180:183], v5 offset:2272
    s_waitcnt lgkmcnt(8)
    v_mfma_f32_32x32x16_bf16 v[152:167], v[184:187], v[192:195], v[152:167]
    v_mfma_f32_32x32x16_bf16 v[136:151], v[184:187], v[188:191], v[136:151]
    v_mfma_f32_32x32x16_bf16 v[152:167], v[196:199], v[188:191], v[152:167]
    ds_read_b128 v[184:187], v5 offset:288
    ds_read_b128 v[192:195], v7 offset:4800
    ds_read_b128 v[188:191], v7 offset:2240
    ds_read_b128 v[196:199], v5 offset:2336
    s_waitcnt lgkmcnt(8)
    v_mfma_f32_32x32x16_bf16 v[152:167], v[200:203], v[208:211], v[152:167]
    v_mfma_f32_32x32x16_bf16 v[136:151], v[200:203], v[204:207], v[136:151]
    v_mfma_f32_32x32x16_bf16 v[152:167], v[212:215], v[204:207], v[152:167]
    ds_read_b128 v[200:203], v5 offset:352
    ds_read_b128 v[208:211], v7 offset:4720
    ds_read_b128 v[204:207], v7 offset:2160
    ds_read_b128 v[212:215], v5 offset:2400
    s_waitcnt lgkmcnt(8)
    v_mfma_f32_32x32x16_bf16 v[152:167], v[168:171], v[176:179], v[152:167]
    v_mfma_f32_32x32x16_bf16 v[136:151], v[168:171], v[172:175], v[136:151]
    v_mfma_f32_32x32x16_bf16 v[152:167], v[180:183], v[172:175], v[152:167]
    ds_read_b128 v[168:171], v5 offset:416
    ds_read_b128 v[176:179], v7 offset:4640
    ds_read_b128 v[172:175], v7 offset:2080
    ds_read_b128 v[180:183], v5 offset:2464
    s_waitcnt lgkmcnt(8)
    v_mfma_f32_32x32x16_bf16 v[152:167], v[184:187], v[192:195], v[152:167]
    v_mfma_f32_32x32x16_bf16 v[136:151], v[184:187], v[188:191], v[136:151]
    v_mfma_f32_32x32x16_bf16 v[152:167], v[196:199], v[188:191], v[152:167]
    ds_read_b128 v[184:187], v5 offset:480
    ds_read_b128 v[192:195], v7 offset:4560
    ds_read_b128 v[188:191], v7 offset:2000
    ds_read_b128 v[196:199], v5 offset:2528
    s_waitcnt lgkmcnt(8)
    v_mfma_f32_32x32x16_bf16 v[152:167], v[200:203], v[208:211], v[152:167]
    v_mfma_f32_32x32x16_bf16 v[136:151], v[200:203], v[204:207], v[136:151]
    v_mfma_f32_32x32x16_bf16 v[152:167], v[212:215], v[204:207], v[152:167]
    ds_read_b128 v[200:203], v5 offset:544
    ds_read_b128 v[208:211], v7 offset:4480
    ds_read_b128 v[204:207], v7 offset:1920
    ds_read_b128 v[212:215], v5 offset:2592
    s_waitcnt lgkmcnt(8)
    v_mfma_f32_32x32x16_bf16 v[152:167], v[168:171], v[176:179], v[152:167]
    v_mfma_f32_32x32x16_bf16 v[136:151], v[168:171], v[172:175], v[136:151]
    v_mfma_f32_32x32x16_bf16 v[152:167], v[180:183], v[172:175], v[152:167]
    ds_read_b128 v[168:171], v5 offset:608
    ds_read_b128 v[176:179], v7 offset:4400
    ds_read_b128 v[172:175], v7 offset:1840
    ds_read_b128 v[180:183], v5 offset:2656
    s_waitcnt lgkmcnt(8)
    v_mfma_f32_32x32x16_bf16 v[152:167], v[184:187], v[192:195], v[152:167]
    v_mfma_f32_32x32x16_bf16 v[136:151], v[184:187], v[188:191], v[136:151]
    v_mfma_f32_32x32x16_bf16 v[152:167], v[196:199], v[188:191], v[152:167]
    ds_read_b128 v[184:187], v5 offset:672
    ds_read_b128 v[192:195], v7 offset:4320
    ds_read_b128 v[188:191], v7 offset:1760
    ds_read_b128 v[196:199], v5 offset:2720
    s_waitcnt lgkmcnt(8)
    v_mfma_f32_32x32x16_bf16 v[152:167], v[200:203], v[208:211], v[152:167]
    v_mfma_f32_32x32x16_bf16 v[136:151], v[200:203], v[204:207], v[136:151]
    v_mfma_f32_32x32x16_bf16 v[152:167], v[212:215], v[204:207], v[152:167]
    ds_read_b128 v[200:203], v5 offset:736
    ds_read_b128 v[208:211], v7 offset:4240
    ds_read_b128 v[204:207], v7 offset:1680
    ds_read_b128 v[212:215], v5 offset:2784
    s_waitcnt lgkmcnt(8)
    v_mfma_f32_32x32x16_bf16 v[152:167], v[168:171], v[176:179], v[152:167]
    v_mfma_f32_32x32x16_bf16 v[136:151], v[168:171], v[172:175], v[136:151]
    v_mfma_f32_32x32x16_bf16 v[152:167], v[180:183], v[172:175], v[152:167]
    ds_read_b128 v[168:171], v5 offset:800
    ds_read_b128 v[176:179], v7 offset:4160
    ds_read_b128 v[172:175], v7 offset:1600
    ds_read_b128 v[180:183], v5 offset:2848
    s_waitcnt lgkmcnt(8)
    v_mfma_f32_32x32x16_bf16 v[152:167], v[184:187], v[192:195], v[152:167]
    v_mfma_f32_32x32x16_bf16 v[136:151], v[184:187], v[188:191], v[136:151]
    v_mfma_f32_32x32x16_bf16 v[152:167], v[196:199], v[188:191], v[152:167]
    ds_read_b128 v[184:187], v5 offset:864
    ds_read_b128 v[192:195], v7 offset:4080
    ds_read_b128 v[188:191], v7 offset:1520
    ds_read_b128 v[196:199], v5 offset:2912
    s_waitcnt lgkmcnt(8)
    v_mfma_f32_32x32x16_bf16 v[152:167], v[200:203], v[208:211], v[152:167]
    v_mfma_f32_32x32x16_bf16 v[136:151], v[200:203], v[204:207], v[136:151]
    v_mfma_f32_32x32x16_bf16 v[152:167], v[212:215], v[204:207], v[152:167]
    ds_read_b128 v[200:203], v5 offset:928
    ds_read_b128 v[208:211], v7 offset:4000
    ds_read_b128 v[204:207], v7 offset:1440
    ds_read_b128 v[212:215], v5 offset:2976
    s_waitcnt lgkmcnt(8)
    v_mfma_f32_32x32x16_bf16 v[152:167], v[168:171], v[176:179], v[152:167]
    v_mfma_f32_32x32x16_bf16 v[136:151], v[168:171], v[172:175], v[136:151]
    v_mfma_f32_32x32x16_bf16 v[152:167], v[180:183], v[172:175], v[152:167]
    ds_read_b128 v[168:171], v5 offset:992
    ds_read_b128 v[176:179], v7 offset:3920
    ds_read_b128 v[172:175], v7 offset:1360
    ds_read_b128 v[180:183], v5 offset:3040
    s_waitcnt lgkmcnt(8)
    v_mfma_f32_32x32x16_bf16 v[152:167], v[184:187], v[192:195], v[152:167]
    v_mfma_f32_32x32x16_bf16 v[136:151], v[184:187], v[188:191], v[136:151]
    v_mfma_f32_32x32x16_bf16 v[152:167], v[196:199], v[188:191], v[152:167]
    s_waitcnt lgkmcnt(4)
    v_mfma_f32_32x32x16_bf16 v[152:167], v[200:203], v[208:211], v[152:167]
    v_mfma_f32_32x32x16_bf16 v[136:151], v[200:203], v[204:207], v[136:151]
    v_mfma_f32_32x32x16_bf16 v[152:167], v[212:215], v[204:207], v[152:167]
    s_waitcnt lgkmcnt(0)
    v_mfma_f32_32x32x16_bf16 v[152:167], v[168:171], v[176:179], v[152:167]
    v_mfma_f32_32x32x16_bf16 v[136:151], v[168:171], v[172:175], v[136:151]
    v_mfma_f32_32x32x16_bf16 v[152:167], v[180:183], v[172:175], v[152:167]
    s_nop 7
    s_nop 7
    s_barrier
    v_and_b32 v5, 7, v3
    v_xor_b32 v5, v5, v4
    v_lshlrev_b32 v5, 4, v5
    v_lshl_add_u32 v5, v3, 7, v5
    v_lshl_add_u32 v5, v1, 13, v5
    v_xor_b32 v8, 0, v5
    v_xor_b32 v9, 32, v5
    v_xor_b32 v10, 64, v5
    v_xor_b32 v11, 96, v5
    ds_write_b128 v8, v[136:139] offset:0
    ds_write_b128 v9, v[140:143] offset:0
    ds_write_b128 v10, v[144:147] offset:0
    ds_write_b128 v11, v[148:151] offset:0
    ds_write_b128 v8, v[152:155] offset:4096
    ds_write_b128 v9, v[156:159] offset:4096
    ds_write_b128 v10, v[160:163] offset:4096
    ds_write_b128 v11, v[164:167] offset:4096
    v_lshrrev_b32 v7, 2, v0
    v_and_b32 v5, 3, v0
    v_lshlrev_b32 v5, 1, v5
    v_and_b32 v13, 7, v7
    v_xor_b32 v5, v5, v13
    v_lshlrev_b32 v5, 4, v5
    v_lshl_add_u32 v5, v7, 7, v5
    v_xor_b32 v7, 16, v5
    s_waitcnt lgkmcnt(0)
    s_barrier
    ds_read_b128 v[40:43], v5 offset:0
    ds_read_b128 v[44:47], v7 offset:0
    ds_read_b128 v[48:51], v5 offset:8192
    ds_read_b128 v[52:55], v7 offset:8192
    ds_read_b128 v[56:59], v5 offset:16384
    ds_read_b128 v[60:63], v7 offset:16384
    ds_read_b128 v[64:67], v5 offset:24576
    ds_read_b128 v[68:71], v7 offset:24576
    s_waitcnt lgkmcnt(0)
    v_add_f32 v40, v40, v48
    v_add_f32 v56, v56, v64
    v_add_f32 v40, v40, v56
    v_cvt_pk_bf16_f32 v40, v40, v40
    v_lshlrev_b32 v40, 16, v40
    v_add_f32 v40, v40, v120
    v_cvt_pk_bf16_f32 v40, v40, v40
    v_lshlrev_b32 v40, 16, v40
    v_add_f32 v40, v40, v104
    v_add_f32 v41, v41, v49
    v_add_f32 v57, v57, v65
    v_add_f32 v41, v41, v57
    v_cvt_pk_bf16_f32 v41, v41, v41
    v_lshlrev_b32 v41, 16, v41
    v_add_f32 v41, v41, v121
    v_cvt_pk_bf16_f32 v41, v41, v41
    v_lshlrev_b32 v41, 16, v41
    v_add_f32 v41, v41, v105
    v_cvt_pk_bf16_f32 v20, v40, v41
    v_add_f32 v42, v42, v50
    v_add_f32 v58, v58, v66
    v_add_f32 v42, v42, v58
    v_cvt_pk_bf16_f32 v42, v42, v42
    v_lshlrev_b32 v42, 16, v42
    v_add_f32 v42, v42, v122
    v_cvt_pk_bf16_f32 v42, v42, v42
    v_lshlrev_b32 v42, 16, v42
    v_add_f32 v42, v42, v106
    v_add_f32 v43, v43, v51
    v_add_f32 v59, v59, v67
    v_add_f32 v43, v43, v59
    v_cvt_pk_bf16_f32 v43, v43, v43
    v_lshlrev_b32 v43, 16, v43
    v_add_f32 v43, v43, v123
    v_cvt_pk_bf16_f32 v43, v43, v43
    v_lshlrev_b32 v43, 16, v43
    v_add_f32 v43, v43, v107
    v_cvt_pk_bf16_f32 v21, v42, v43
    v_add_f32 v44, v44, v52
    v_add_f32 v60, v60, v68
    v_add_f32 v44, v44, v60
    v_cvt_pk_bf16_f32 v44, v44, v44
    v_lshlrev_b32 v44, 16, v44
    v_add_f32 v44, v44, v124
    v_cvt_pk_bf16_f32 v44, v44, v44
    v_lshlrev_b32 v44, 16, v44
    v_add_f32 v44, v44, v108
    v_add_f32 v45, v45, v53
    v_add_f32 v61, v61, v69
    v_add_f32 v45, v45, v61
    v_cvt_pk_bf16_f32 v45, v45, v45
    v_lshlrev_b32 v45, 16, v45
    v_add_f32 v45, v45, v125
    v_cvt_pk_bf16_f32 v45, v45, v45
    v_lshlrev_b32 v45, 16, v45
    v_add_f32 v45, v45, v109
    v_cvt_pk_bf16_f32 v22, v44, v45
    v_add_f32 v46, v46, v54
    v_add_f32 v62, v62, v70
    v_add_f32 v46, v46, v62
    v_cvt_pk_bf16_f32 v46, v46, v46
    v_lshlrev_b32 v46, 16, v46
    v_add_f32 v46, v46, v126
    v_cvt_pk_bf16_f32 v46, v46, v46
    v_lshlrev_b32 v46, 16, v46
    v_add_f32 v46, v46, v110
    v_add_f32 v47, v47, v55
    v_add_f32 v63, v63, v71
    v_add_f32 v47, v47, v63
    v_cvt_pk_bf16_f32 v47, v47, v47
    v_lshlrev_b32 v47, 16, v47
    v_add_f32 v47, v47, v127
    v_cvt_pk_bf16_f32 v47, v47, v47
    v_lshlrev_b32 v47, 16, v47
    v_add_f32 v47, v47, v111
    v_cvt_pk_bf16_f32 v23, v46, v47
    v_lshlrev_b32 v4, 4, v0
    buffer_store_dwordx4 v[20:23], v4, s[8:11], s5 offen
L_end_conv1_kernel:
    s_endpgm
.section .rodata,"a"
.p2align 6
.amdhsa_kernel conv1_kernel
  .amdhsa_next_free_vgpr 216
  .amdhsa_next_free_sgpr 96
  .amdhsa_accum_offset 216
  .amdhsa_group_segment_fixed_size 0
  .amdhsa_kernarg_size 120
  .amdhsa_user_sgpr_count 2
  .amdhsa_user_sgpr_kernarg_segment_ptr 1
  .amdhsa_system_sgpr_workgroup_id_x 1
.end_amdhsa_kernel
.text

.globl conv2_kernel
.p2align 8
.type conv2_kernel,@function
conv2_kernel:
    s_cmp_ge_u32 s2, 512
    s_cbranch_scc1 L_end_conv2_kernel
    s_load_dwordx2 s[8:9], s[0:1], 112
    s_mov_b32 s10, 25165824
    s_mov_b32 s11, 0x00020000
    s_load_dwordx2 s[12:13], s[0:1], 64
    s_mov_b32 s14, 1024
    s_mov_b32 s15, 0x00020000
    v_lshrrev_b32 v1, 6, v0
    v_and_b32 v2, 63, v0
    s_lshl_b32 s3, s2, 13
    s_add_u32 s3, s3, 9437184
    s_lshl_b32 s4, s2, 12
    s_add_u32 s5, s4, 6291456
    s_add_u32 s4, s4, 4194304
    s_lshl_b32 s6, s2, 1
    s_mov_b32 s7, 8454144
    s_waitcnt lgkmcnt(0)
    v_lshlrev_b32 v3, 4, v0
    buffer_load_dwordx4 v[16:19], v3, s[8:11], s3 offen
    buffer_load_dwordx4 v[32:35], v3, s[8:11], s4 offen
    v_mov_b32 v5, s6
    buffer_load_ushort v6, v5, s[12:15], 0 offen
    s_add_u32 s20, s7, 0
    buffer_load_dwordx4 v[40:43], v3, s[8:11], s20 offen
    s_add_u32 s21, s7, 4096
    buffer_load_dwordx4 v[44:47], v3, s[8:11], s21 offen
    s_add_u32 s22, s7, 8192
    buffer_load_dwordx4 v[48:51], v3, s[8:11], s22 offen
    s_add_u32 s23, s7, 12288
    buffer_load_dwordx4 v[52:55], v3, s[8:11], s23 offen
    s_add_u32 s24, s7, 16384
    buffer_load_dwordx4 v[72:75], v3, s[8:11], s24 offen
    s_add_u32 s25, s7, 20480
    buffer_load_dwordx4 v[76:79], v3, s[8:11], s25 offen
    s_add_u32 s26, s7, 24576
    buffer_load_dwordx4 v[80:83], v3, s[8:11], s26 offen
    s_add_u32 s27, s7, 28672
    buffer_load_dwordx4 v[84:87], v3, s[8:11], s27 offen
    s_add_u32 s28, s7, 32768
    buffer_load_dwordx4 v[56:59], v3, s[8:11], s28 offen
    s_add_u32 s29, s7, 36864
    buffer_load_dwordx4 v[60:63], v3, s[8:11], s29 offen
    s_add_u32 s30, s7, 40960
    buffer_load_dwordx4 v[64:67], v3, s[8:11], s30 offen
    s_add_u32 s31, s7, 45056
    buffer_load_dwordx4 v[68:71], v3, s[8:11], s31 offen
    s_add_u32 s32, s7, 49152
    buffer_load_dwordx4 v[88:91], v3, s[8:11], s32 offen
    s_add_u32 s33, s7, 53248
    buffer_load_dwordx4 v[92:95], v3, s[8:11], s33 offen
    s_add_u32 s34, s7, 57344
    buffer_load_dwordx4 v[96:99], v3, s[8:11], s34 offen
    s_add_u32 s35, s7, 61440
    buffer_load_dwordx4 v[100:103], v3, s[8:11], s35 offen
    v_mov_b32 v8, 0
    v_mov_b32 v9, 0
    v_mov_b32 v10, 0
    v_mov_b32 v11, 0
    v_mov_b32 v12, 33280
    v_min_u32 v13, 0x9f, v0
    v_lshl_add_u32 v13, v13, 4, v12
    ds_write_b128 v13, v[8:11]
    v_lshrrev_b32 v14, 2, v2
    v_and_b32 v14, 7, v14
    s_mov_b32 s16, 4160
    v_mul_lo_u32 v14, v14, s16
    v_and_b32 v15, 3, v2
    v_lshl_add_u32 v14, v15, 4, v14
    ds_write_b128 v14, v[8:11]
    v_lshrrev_b32 v14, 2, v0
    s_mov_b32 s16, 80
    v_mul_lo_u32 v14, v14, s16
    v_lshl_add_u32 v14, v15, 4, v14
    v_add_u32 v14, v12, v14
    s_waitcnt vmcnt(18)
    ds_write_b128 v14, v[16:19] offset:2560
    s_waitcnt vmcnt(0)
    v_lshlrev_b32 v6, 16, v6
    s_mov_b32 s16, 0x3b000000
    s_mov_b32 s17, 0x3727c5ac
    v_pk_add_f32 v[72:73], v[72:73], v[88:89]
    v_pk_add_f32 v[40:41], v[40:41], v[56:57]
    v_pk_add_f32 v[40:41], v[40:41], v[72:73]
    v_mul_f32 v40, s16, v40
    v_mul_f32 v41, s16, v41
    v_fma_f32 v41, -v40, v40, v41
    v_max_f32 v41, 0, v41
    v_cvt_pk_bf16_f32 v40, v40, v40
    v_lshlrev_b32 v40, 16, v40
    v_cvt_pk_bf16_f32 v41, v41, v41
    v_lshlrev_b32 v41, 16, v41
    v_add_f32 v41, s17, v41
    v_cvt_pk_bf16_f32 v41, v41, v41
    v_lshlrev_b32 v41, 16, v41
    v_sqrt_f32 v41, v41
    s_nop 0
    v_cvt_pk_bf16_f32 v41, v41, v41
    v_lshlrev_b32 v41, 16, v41
    v_rcp_f32 v41, v41
    v_lshlrev_b32 v104, 16, v32
    v_sub_f32 v40, v104, v40
    v_cvt_pk_bf16_f32 v40, v40, v40
    v_lshlrev_b32 v40, 16, v40
    v_mul_f32 v40, v40, v41
    v_cvt_pk_bf16_f32 v40, v40, v40
    v_lshlrev_b32 v40, 16, v40
    v_mul_f32 v120, v40, v6
    v_cvt_pk_bf16_f32 v120, v120, v120
    v_lshlrev_b32 v120, 16, v120
    v_pk_add_f32 v[74:75], v[74:75], v[90:91]
    v_pk_add_f32 v[42:43], v[42:43], v[58:59]
    v_pk_add_f32 v[42:43], v[42:43], v[74:75]
    v_mul_f32 v42, s16, v42
    v_mul_f32 v43, s16, v43
    v_fma_f32 v43, -v42, v42, v43
    v_max_f32 v43, 0, v43
    v_cvt_pk_bf16_f32 v42, v42, v42
    v_lshlrev_b32 v42, 16, v42
    v_cvt_pk_bf16_f32 v43, v43, v43
    v_lshlrev_b32 v43, 16, v43
    v_add_f32 v43, s17, v43
    v_cvt_pk_bf16_f32 v43, v43, v43
    v_lshlrev_b32 v43, 16, v43
    v_sqrt_f32 v43, v43
    s_nop 0
    v_cvt_pk_bf16_f32 v43, v43, v43
    v_lshlrev_b32 v43, 16, v43
    v_rcp_f32 v43, v43
    v_and_b32 v105, 0xffff0000, v32
    v_sub_f32 v42, v105, v42
    v_cvt_pk_bf16_f32 v42, v42, v42
    v_lshlrev_b32 v42, 16, v42
    v_mul_f32 v42, v42, v43
    v_cvt_pk_bf16_f32 v42, v42, v42
    v_lshlrev_b32 v42, 16, v42
    v_mul_f32 v121, v42, v6
    v_cvt_pk_bf16_f32 v121, v121, v121
    v_lshlrev_b32 v121, 16, v121
    v_cvt_pk_bf16_f32 v20, v40, v42
    v_pk_add_f32 v[76:77], v[76:77], v[92:93]
    v_pk_add_f32 v[44:45], v[44:45], v[60:61]
    v_pk_add_f32 v[44:45], v[44:45], v[76:77]
    v_mul_f32 v44, s16, v44
    v_mul_f32 v45, s16, v45
    v_fma_f32 v45, -v44, v44, v45
    v_max_f32 v45, 0, v45
    v_cvt_pk_bf16_f32 v44, v44, v44
    v_lshlrev_b32 v44, 16, v44
    v_cvt_pk_bf16_f32 v45, v45, v45
    v_lshlrev_b32 v45, 16, v45
    v_add_f32 v45, s17, v45
    v_cvt_pk_bf16_f32 v45, v45, v45
    v_lshlrev_b32 v45, 16, v45
    v_sqrt_f32 v45, v45
    s_nop 0
    v_cvt_pk_bf16_f32 v45, v45, v45
    v_lshlrev_b32 v45, 16, v45
    v_rcp_f32 v45, v45
    v_lshlrev_b32 v106, 16, v33
    v_sub_f32 v44, v106, v44
    v_cvt_pk_bf16_f32 v44, v44, v44
    v_lshlrev_b32 v44, 16, v44
    v_mul_f32 v44, v44, v45
    v_cvt_pk_bf16_f32 v44, v44, v44
    v_lshlrev_b32 v44, 16, v44
    v_mul_f32 v122, v44, v6
    v_cvt_pk_bf16_f32 v122, v122, v122
    v_lshlrev_b32 v122, 16, v122
    v_pk_add_f32 v[78:79], v[78:79], v[94:95]
    v_pk_add_f32 v[46:47], v[46:47], v[62:63]
    v_pk_add_f32 v[46:47], v[46:47], v[78:79]
    v_mul_f32 v46, s16, v46
    v_mul_f32 v47, s16, v47
    v_fma_f32 v47, -v46, v46, v47
    v_max_f32 v47, 0, v47
    v_cvt_pk_bf16_f32 v46, v46, v46
    v_lshlrev_b32 v46, 16, v46
    v_cvt_pk_bf16_f32 v47, v47, v47
    v_lshlrev_b32 v47, 16, v47
    v_add_f32 v47, s17, v47
    v_cvt_pk_bf16_f32 v47, v47, v47
    v_lshlrev_b32 v47, 16, v47
    v_sqrt_f32 v47, v47
    s_nop 0
    v_cvt_pk_bf16_f32 v47, v47, v47
    v_lshlrev_b32 v47, 16, v47
    v_rcp_f32 v47, v47
    v_and_b32 v107, 0xffff0000, v33
    v_sub_f32 v46, v107, v46
    v_cvt_pk_bf16_f32 v46, v46, v46
    v_lshlrev_b32 v46, 16, v46
    v_mul_f32 v46, v46, v47
    v_cvt_pk_bf16_f32 v46, v46, v46
    v_lshlrev_b32 v46, 16, v46
    v_mul_f32 v123, v46, v6
    v_cvt_pk_bf16_f32 v123, v123, v123
    v_lshlrev_b32 v123, 16, v123
    v_cvt_pk_bf16_f32 v21, v44, v46
    v_pk_add_f32 v[80:81], v[80:81], v[96:97]
    v_pk_add_f32 v[48:49], v[48:49], v[64:65]
    v_pk_add_f32 v[48:49], v[48:49], v[80:81]
    v_mul_f32 v48, s16, v48
    v_mul_f32 v49, s16, v49
    v_fma_f32 v49, -v48, v48, v49
    v_max_f32 v49, 0, v49
    v_cvt_pk_bf16_f32 v48, v48, v48
    v_lshlrev_b32 v48, 16, v48
    v_cvt_pk_bf16_f32 v49, v49, v49
    v_lshlrev_b32 v49, 16, v49
    v_add_f32 v49, s17, v49
    v_cvt_pk_bf16_f32 v49, v49, v49
    v_lshlrev_b32 v49, 16, v49
    v_sqrt_f32 v49, v49
    s_nop 0
    v_cvt_pk_bf16_f32 v49, v49, v49
    v_lshlrev_b32 v49, 16, v49
    v_rcp_f32 v49, v49
    v_lshlrev_b32 v108, 16, v34
    v_sub_f32 v48, v108, v48
    v_cvt_pk_bf16_f32 v48, v48, v48
    v_lshlrev_b32 v48, 16, v48
    v_mul_f32 v48, v48, v49
    v_cvt_pk_bf16_f32 v48, v48, v48
    v_lshlrev_b32 v48, 16, v48
    v_mul_f32 v124, v48, v6
    v_cvt_pk_bf16_f32 v124, v124, v124
    v_lshlrev_b32 v124, 16, v124
    v_pk_add_f32 v[82:83], v[82:83], v[98:99]
    v_pk_add_f32 v[50:51], v[50:51], v[66:67]
    v_pk_add_f32 v[50:51], v[50:51], v[82:83]
    v_mul_f32 v50, s16, v50
    v_mul_f32 v51, s16, v51
    v_fma_f32 v51, -v50, v50, v51
    v_max_f32 v51, 0, v51
    v_cvt_pk_bf16_f32 v50, v50, v50
    v_lshlrev_b32 v50, 16, v50
    v_cvt_pk_bf16_f32 v51, v51, v51
    v_lshlrev_b32 v51, 16, v51
    v_add_f32 v51, s17, v51
    v_cvt_pk_bf16_f32 v51, v51, v51
    v_lshlrev_b32 v51, 16, v51
    v_sqrt_f32 v51, v51
    s_nop 0
    v_cvt_pk_bf16_f32 v51, v51, v51
    v_lshlrev_b32 v51, 16, v51
    v_rcp_f32 v51, v51
    v_and_b32 v109, 0xffff0000, v34
    v_sub_f32 v50, v109, v50
    v_cvt_pk_bf16_f32 v50, v50, v50
    v_lshlrev_b32 v50, 16, v50
    v_mul_f32 v50, v50, v51
    v_cvt_pk_bf16_f32 v50, v50, v50
    v_lshlrev_b32 v50, 16, v50
    v_mul_f32 v125, v50, v6
    v_cvt_pk_bf16_f32 v125, v125, v125
    v_lshlrev_b32 v125, 16, v125
    v_cvt_pk_bf16_f32 v22, v48, v50
    v_pk_add_f32 v[84:85], v[84:85], v[100:101]
    v_pk_add_f32 v[52:53], v[52:53], v[68:69]
    v_pk_add_f32 v[52:53], v[52:53], v[84:85]
    v_mul_f32 v52, s16, v52
    v_mul_f32 v53, s16, v53
    v_fma_f32 v53, -v52, v52, v53
    v_max_f32 v53, 0, v53
    v_cvt_pk_bf16_f32 v52, v52, v52
    v_lshlrev_b32 v52, 16, v52
    v_cvt_pk_bf16_f32 v53, v53, v53
    v_lshlrev_b32 v53, 16, v53
    v_add_f32 v53, s17, v53
    v_cvt_pk_bf16_f32 v53, v53, v53
    v_lshlrev_b32 v53, 16, v53
    v_sqrt_f32 v53, v53
    s_nop 0
    v_cvt_pk_bf16_f32 v53, v53, v53
    v_lshlrev_b32 v53, 16, v53
    v_rcp_f32 v53, v53
    v_lshlrev_b32 v110, 16, v35
    v_sub_f32 v52, v110, v52
    v_cvt_pk_bf16_f32 v52, v52, v52
    v_lshlrev_b32 v52, 16, v52
    v_mul_f32 v52, v52, v53
    v_cvt_pk_bf16_f32 v52, v52, v52
    v_lshlrev_b32 v52, 16, v52
    v_mul_f32 v126, v52, v6
    v_cvt_pk_bf16_f32 v126, v126, v126
    v_lshlrev_b32 v126, 16, v126
    v_pk_add_f32 v[86:87], v[86:87], v[102:103]
    v_pk_add_f32 v[54:55], v[54:55], v[70:71]
    v_pk_add_f32 v[54:55], v[54:55], v[86:87]
    v_mul_f32 v54, s16, v54
    v_mul_f32 v55, s16, v55
    v_fma_f32 v55, -v54, v54, v55
    v_max_f32 v55, 0, v55
    v_cvt_pk_bf16_f32 v54, v54, v54
    v_lshlrev_b32 v54, 16, v54
    v_cvt_pk_bf16_f32 v55, v55, v55
    v_lshlrev_b32 v55, 16, v55
    v_add_f32 v55, s17, v55
    v_cvt_pk_bf16_f32 v55, v55, v55
    v_lshlrev_b32 v55, 16, v55
    v_sqrt_f32 v55, v55
    s_nop 0
    v_cvt_pk_bf16_f32 v55, v55, v55
    v_lshlrev_b32 v55, 16, v55
    v_rcp_f32 v55, v55
    v_and_b32 v111, 0xffff0000, v35
    v_sub_f32 v54, v111, v54
    v_cvt_pk_bf16_f32 v54, v54, v54
    v_lshlrev_b32 v54, 16, v54
    v_mul_f32 v54, v54, v55
    v_cvt_pk_bf16_f32 v54, v54, v54
    v_lshlrev_b32 v54, 16, v54
    v_mul_f32 v127, v54, v6
    v_cvt_pk_bf16_f32 v127, v127, v127
    v_lshlrev_b32 v127, 16, v127
    v_cvt_pk_bf16_f32 v23, v52, v54
    ds_write_b128 v3, v[20:23] offset:48656
    v_mov_b32 v15, 0
    ds_write_b128 v15, v[8:11] offset:48640
    s_waitcnt lgkmcnt(0)
    s_barrier
    ds_read_b128 v[16:19], v3 offset:48640
    s_waitcnt lgkmcnt(0)
    v_alignbit_b32 v40, v17, v16, 16
    v_alignbit_b32 v41, v18, v17, 16
    v_alignbit_b32 v42, v19, v18, 16
    v_alignbit_b32 v43, v20, v19, 16
    v_alignbit_b32 v44, v21, v20, 16
    v_alignbit_b32 v45, v22, v21, 16
    v_alignbit_b32 v46, v23, v22, 16
    ds_write_b128 v3, v[40:43] offset:64
    v_mov_b32 v48, v17
    v_mov_b32 v49, v18
    v_mov_b32 v50, v19
    v_mov_b32 v51, v20
    ds_write_b128 v3, v[48:51] offset:4224
    v_mov_b32 v52, v41
    v_mov_b32 v53, v42
    v_mov_b32 v54, v43
    v_mov_b32 v55, v44
    ds_write_b128 v3, v[52:55] offset:8384
    ds_write_b128 v3, v[18:21] offset:12544
    ds_write_b128 v3, v[42:45] offset:16704
    v_mov_b32 v56, v19
    v_mov_b32 v57, v20
    v_mov_b32 v58, v21
    v_mov_b32 v59, v22
    ds_write_b128 v3, v[56:59] offset:20864
    v_mov_b32 v60, v43
    v_mov_b32 v61, v44
    v_mov_b32 v62, v45
    v_mov_b32 v63, v46
    ds_write_b128 v3, v[60:63] offset:25024
    ds_write_b128 v3, v[20:23] offset:29184
    v_and_b32 v3, 31, v2
    v_lshrrev_b32 v4, 5, v2
    v_and_b32 v5, 7, v3
    v_lshrrev_b32 v7, 3, v3
    s_mov_b32 s16, 4160
    v_mul_lo_u32 v5, v5, s16
    v_sub_u32 v7, v7, v4
    v_add_u32 v7, 2, v7
    v_lshl_add_u32 v5, v7, 4, v5
    v_and_b32 v14, 1, v1
    v_lshrrev_b32 v15, 1, v1
    s_mov_b32 s16, 80
    v_mul_lo_u32 v7, v3, s16
    v_lshl_add_u32 v7, v4, 4, v7
    v_add_u32 v7, v12, v7
    v_lshl_add_u32 v7, v14, 5, v7
    v_lshlrev_b32 v13, 5, v14
    v_sub_u32 v5, v5, v13
    v_lshl_add_u32 v5, v15, 10, v5
    s_movk_i32 s16, 1280
    v_mul_lo_u32 v15, v15, s16
    v_sub_u32 v7, v7, v15
    s_waitcnt lgkmcnt(0)
    s_barrier
    ds_read_b128 v[168:171], v5 offset:32
    ds_read_b128 v[176:179], v7 offset:5120
    ds_read_b128 v[172:175], v7 offset:2560
    ds_read_b128 v[180:183], v5 offset:2080
    ds_read_b128 v[184:187], v5 offset:96
    ds_read_b128 v[192:195], v7 offset:5040
    ds_read_b128 v[188:191], v7 offset:2480
    ds_read_b128 v[196:199], v5 offset:2144
    ds_read_b128 v[200:203], v5 offset:160
    ds_read_b128 v[208:211], v7 offset:4960
    ds_read_b128 v[204:207], v7 offset:2400
    ds_read_b128 v[212:215], v5 offset:2208
    s_waitcnt lgkmcnt(8)
    v_mfma_f32_32x32x16_bf16 v[152:167], v[168:171], v[176:179], 0
    v_mfma_f32_32x32x16_bf16 v[136:151], v[168:171], v[172:175], 0
    v_mfma_f32_32x32x16_bf16 v[152:167], v[180:183], v[172:175], v[152:167]
    ds_read_b128 v[168:171], v5 offset:224
    ds_read_b128 v[176:179], v7 offset:4880
    ds_read_b128 v[172:175], v7 offset:2320
    ds_read_b128 v[180:183], v5 offset:2272
    s_waitcnt lgkmcnt(8)
    v_mfma_f32_32x32x16_bf16 v[152:167], v[184:187], v[192:195], v[152:167]
    v_mfma_f32_32x32x16_bf16 v[136:151], v[184:187], v[188:191], v[136:151]
    v_mfma_f32_32x32x16_bf16 v[152:167], v[196:199], v[188:191], v[152:167]
    ds_read_b128 v[184:187], v5 offset:288
    ds_read_b128 v[192:195], v7 offset:4800
    ds_read_b128 v[188:191], v7 offset:2240
    ds_read_b128 v[196:199], v5 offset:2336
    s_waitcnt lgkmcnt(8)
    v_mfma_f32_32x32x16_bf16 v[152:167], v[200:203], v[208:211], v[152:167]
    v_mfma_f32_32x32x16_bf16 v[136:151], v[200:203], v[204:207], v[136:151]
    v_mfma_f32_32x32x16_bf16 v[152:167], v[212:215], v[204:207], v[152:167]
    ds_read_b128 v[200:203], v5 offset:352
    ds_read_b128 v[208:211], v7 offset:4720
    ds_read_b128 v[204:207], v7 offset:2160
    ds_read_b128 v[212:215], v5 offset:2400
    s_waitcnt lgkmcnt(8)
    v_mfma_f32_32x32x16_bf16 v[152:167], v[168:171], v[176:179], v[152:167]
    v_mfma_f32_32x32x16_bf16 v[136:151], v[168:171], v[172:175], v[136:151]
    v_mfma_f32_32x32x16_bf16 v[152:167], v[180:183], v[172:175], v[152:167]
    ds_read_b128 v[168:171], v5 offset:416
    ds_read_b128 v[176:179], v7 offset:4640
    ds_read_b128 v[172:175], v7 offset:2080
    ds_read_b128 v[180:183], v5 offset:2464
    s_waitcnt lgkmcnt(8)
    v_mfma_f32_32x32x16_bf16 v[152:167], v[184:187], v[192:195], v[152:167]
    v_mfma_f32_32x32x16_bf16 v[136:151], v[184:187], v[188:191], v[136:151]
    v_mfma_f32_32x32x16_bf16 v[152:167], v[196:199], v[188:191], v[152:167]
    ds_read_b128 v[184:187], v5 offset:480
    ds_read_b128 v[192:195], v7 offset:4560
    ds_read_b128 v[188:191], v7 offset:2000
    ds_read_b128 v[196:199], v5 offset:2528
    s_waitcnt lgkmcnt(8)
    v_mfma_f32_32x32x16_bf16 v[152:167], v[200:203], v[208:211], v[152:167]
    v_mfma_f32_32x32x16_bf16 v[136:151], v[200:203], v[204:207], v[136:151]
    v_mfma_f32_32x32x16_bf16 v[152:167], v[212:215], v[204:207], v[152:167]
    ds_read_b128 v[200:203], v5 offset:544
    ds_read_b128 v[208:211], v7 offset:4480
    ds_read_b128 v[204:207], v7 offset:1920
    ds_read_b128 v[212:215], v5 offset:2592
    s_waitcnt lgkmcnt(8)
    v_mfma_f32_32x32x16_bf16 v[152:167], v[168:171], v[176:179], v[152:167]
    v_mfma_f32_32x32x16_bf16 v[136:151], v[168:171], v[172:175], v[136:151]
    v_mfma_f32_32x32x16_bf16 v[152:167], v[180:183], v[172:175], v[152:167]
    ds_read_b128 v[168:171], v5 offset:608
    ds_read_b128 v[176:179], v7 offset:4400
    ds_read_b128 v[172:175], v7 offset:1840
    ds_read_b128 v[180:183], v5 offset:2656
    s_waitcnt lgkmcnt(8)
    v_mfma_f32_32x32x16_bf16 v[152:167], v[184:187], v[192:195], v[152:167]
    v_mfma_f32_32x32x16_bf16 v[136:151], v[184:187], v[188:191], v[136:151]
    v_mfma_f32_32x32x16_bf16 v[152:167], v[196:199], v[188:191], v[152:167]
    ds_read_b128 v[184:187], v5 offset:672
    ds_read_b128 v[192:195], v7 offset:4320
    ds_read_b128 v[188:191], v7 offset:1760
    ds_read_b128 v[196:199], v5 offset:2720
    s_waitcnt lgkmcnt(8)
    v_mfma_f32_32x32x16_bf16 v[152:167], v[200:203], v[208:211], v[152:167]
    v_mfma_f32_32x32x16_bf16 v[136:151], v[200:203], v[204:207], v[136:151]
    v_mfma_f32_32x32x16_bf16 v[152:167], v[212:215], v[204:207], v[152:167]
    ds_read_b128 v[200:203], v5 offset:736
    ds_read_b128 v[208:211], v7 offset:4240
    ds_read_b128 v[204:207], v7 offset:1680
    ds_read_b128 v[212:215], v5 offset:2784
    s_waitcnt lgkmcnt(8)
    v_mfma_f32_32x32x16_bf16 v[152:167], v[168:171], v[176:179], v[152:167]
    v_mfma_f32_32x32x16_bf16 v[136:151], v[168:171], v[172:175], v[136:151]
    v_mfma_f32_32x32x16_bf16 v[152:167], v[180:183], v[172:175], v[152:167]
    ds_read_b128 v[168:171], v5 offset:800
    ds_read_b128 v[176:179], v7 offset:4160
    ds_read_b128 v[172:175], v7 offset:1600
    ds_read_b128 v[180:183], v5 offset:2848
    s_waitcnt lgkmcnt(8)
    v_mfma_f32_32x32x16_bf16 v[152:167], v[184:187], v[192:195], v[152:167]
    v_mfma_f32_32x32x16_bf16 v[136:151], v[184:187], v[188:191], v[136:151]
    v_mfma_f32_32x32x16_bf16 v[152:167], v[196:199], v[188:191], v[152:167]
    ds_read_b128 v[184:187], v5 offset:864
    ds_read_b128 v[192:195], v7 offset:4080
    ds_read_b128 v[188:191], v7 offset:1520
    ds_read_b128 v[196:199], v5 offset:2912
    s_waitcnt lgkmcnt(8)
    v_mfma_f32_32x32x16_bf16 v[152:167], v[200:203], v[208:211], v[152:167]
    v_mfma_f32_32x32x16_bf16 v[136:151], v[200:203], v[204:207], v[136:151]
    v_mfma_f32_32x32x16_bf16 v[152:167], v[212:215], v[204:207], v[152:167]
    ds_read_b128 v[200:203], v5 offset:928
    ds_read_b128 v[208:211], v7 offset:4000
    ds_read_b128 v[204:207], v7 offset:1440
    ds_read_b128 v[212:215], v5 offset:2976
    s_waitcnt lgkmcnt(8)
    v_mfma_f32_32x32x16_bf16 v[152:167], v[168:171], v[176:179], v[152:167]
    v_mfma_f32_32x32x16_bf16 v[136:151], v[168:171], v[172:175], v[136:151]
    v_mfma_f32_32x32x16_bf16 v[152:167], v[180:183], v[172:175], v[152:167]
    ds_read_b128 v[168:171], v5 offset:992
    ds_read_b128 v[176:179], v7 offset:3920
    ds_read_b128 v[172:175], v7 offset:1360
    ds_read_b128 v[180:183], v5 offset:3040
    s_waitcnt lgkmcnt(8)
    v_mfma_f32_32x32x16_bf16 v[152:167], v[184:187], v[192:195], v[152:167]
    v_mfma_f32_32x32x16_bf16 v[136:151], v[184:187], v[188:191], v[136:151]
    v_mfma_f32_32x32x16_bf16 v[152:167], v[196:199], v[188:191], v[152:167]
    s_waitcnt lgkmcnt(4)
    v_mfma_f32_32x32x16_bf16 v[152:167], v[200:203], v[208:211], v[152:167]
    v_mfma_f32_32x32x16_bf16 v[136:151], v[200:203], v[204:207], v[136:151]
    v_mfma_f32_32x32x16_bf16 v[152:167], v[212:215], v[204:207], v[152:167]
    s_waitcnt lgkmcnt(0)
    v_mfma_f32_32x32x16_bf16 v[152:167], v[168:171], v[176:179], v[152:167]
    v_mfma_f32_32x32x16_bf16 v[136:151], v[168:171], v[172:175], v[136:151]
    v_mfma_f32_32x32x16_bf16 v[152:167], v[180:183], v[172:175], v[152:167]
    s_nop 7
    s_nop 7
    s_barrier
    v_and_b32 v5, 7, v3
    v_xor_b32 v5, v5, v4
    v_lshlrev_b32 v5, 4, v5
    v_lshl_add_u32 v5, v3, 7, v5
    v_lshl_add_u32 v5, v1, 13, v5
    v_xor_b32 v8, 0, v5
    v_xor_b32 v9, 32, v5
    v_xor_b32 v10, 64, v5
    v_xor_b32 v11, 96, v5
    ds_write_b128 v8, v[136:139] offset:0
    ds_write_b128 v9, v[140:143] offset:0
    ds_write_b128 v10, v[144:147] offset:0
    ds_write_b128 v11, v[148:151] offset:0
    ds_write_b128 v8, v[152:155] offset:4096
    ds_write_b128 v9, v[156:159] offset:4096
    ds_write_b128 v10, v[160:163] offset:4096
    ds_write_b128 v11, v[164:167] offset:4096
    v_lshrrev_b32 v7, 2, v0
    v_and_b32 v5, 3, v0
    v_lshlrev_b32 v5, 1, v5
    v_and_b32 v13, 7, v7
    v_xor_b32 v5, v5, v13
    v_lshlrev_b32 v5, 4, v5
    v_lshl_add_u32 v5, v7, 7, v5
    v_xor_b32 v7, 16, v5
    s_waitcnt lgkmcnt(0)
    s_barrier
    ds_read_b128 v[40:43], v5 offset:0
    ds_read_b128 v[44:47], v7 offset:0
    ds_read_b128 v[48:51], v5 offset:8192
    ds_read_b128 v[52:55], v7 offset:8192
    ds_read_b128 v[56:59], v5 offset:16384
    ds_read_b128 v[60:63], v7 offset:16384
    ds_read_b128 v[64:67], v5 offset:24576
    ds_read_b128 v[68:71], v7 offset:24576
    s_waitcnt lgkmcnt(0)
    v_add_f32 v40, v40, v48
    v_add_f32 v56, v56, v64
    v_add_f32 v40, v40, v56
    v_cvt_pk_bf16_f32 v40, v40, v40
    v_lshlrev_b32 v40, 16, v40
    v_add_f32 v40, v40, v120
    v_cvt_pk_bf16_f32 v40, v40, v40
    v_lshlrev_b32 v40, 16, v40
    v_add_f32 v40, v40, v104
    v_add_f32 v41, v41, v49
    v_add_f32 v57, v57, v65
    v_add_f32 v41, v41, v57
    v_cvt_pk_bf16_f32 v41, v41, v41
    v_lshlrev_b32 v41, 16, v41
    v_add_f32 v41, v41, v121
    v_cvt_pk_bf16_f32 v41, v41, v41
    v_lshlrev_b32 v41, 16, v41
    v_add_f32 v41, v41, v105
    v_cvt_pk_bf16_f32 v20, v40, v41
    v_add_f32 v42, v42, v50
    v_add_f32 v58, v58, v66
    v_add_f32 v42, v42, v58
    v_cvt_pk_bf16_f32 v42, v42, v42
    v_lshlrev_b32 v42, 16, v42
    v_add_f32 v42, v42, v122
    v_cvt_pk_bf16_f32 v42, v42, v42
    v_lshlrev_b32 v42, 16, v42
    v_add_f32 v42, v42, v106
    v_add_f32 v43, v43, v51
    v_add_f32 v59, v59, v67
    v_add_f32 v43, v43, v59
    v_cvt_pk_bf16_f32 v43, v43, v43
    v_lshlrev_b32 v43, 16, v43
    v_add_f32 v43, v43, v123
    v_cvt_pk_bf16_f32 v43, v43, v43
    v_lshlrev_b32 v43, 16, v43
    v_add_f32 v43, v43, v107
    v_cvt_pk_bf16_f32 v21, v42, v43
    v_add_f32 v44, v44, v52
    v_add_f32 v60, v60, v68
    v_add_f32 v44, v44, v60
    v_cvt_pk_bf16_f32 v44, v44, v44
    v_lshlrev_b32 v44, 16, v44
    v_add_f32 v44, v44, v124
    v_cvt_pk_bf16_f32 v44, v44, v44
    v_lshlrev_b32 v44, 16, v44
    v_add_f32 v44, v44, v108
    v_add_f32 v45, v45, v53
    v_add_f32 v61, v61, v69
    v_add_f32 v45, v45, v61
    v_cvt_pk_bf16_f32 v45, v45, v45
    v_lshlrev_b32 v45, 16, v45
    v_add_f32 v45, v45, v125
    v_cvt_pk_bf16_f32 v45, v45, v45
    v_lshlrev_b32 v45, 16, v45
    v_add_f32 v45, v45, v109
    v_cvt_pk_bf16_f32 v22, v44, v45
    v_add_f32 v46, v46, v54
    v_add_f32 v62, v62, v70
    v_add_f32 v46, v46, v62
    v_cvt_pk_bf16_f32 v46, v46, v46
    v_lshlrev_b32 v46, 16, v46
    v_add_f32 v46, v46, v126
    v_cvt_pk_bf16_f32 v46, v46, v46
    v_lshlrev_b32 v46, 16, v46
    v_add_f32 v46, v46, v110
    v_add_f32 v47, v47, v55
    v_add_f32 v63, v63, v71
    v_add_f32 v47, v47, v63
    v_cvt_pk_bf16_f32 v47, v47, v47
    v_lshlrev_b32 v47, 16, v47
    v_add_f32 v47, v47, v127
    v_cvt_pk_bf16_f32 v47, v47, v47
    v_lshlrev_b32 v47, 16, v47
    v_add_f32 v47, v47, v111
    v_cvt_pk_bf16_f32 v23, v46, v47
    v_lshlrev_b32 v4, 4, v0
    buffer_store_dwordx4 v[20:23], v4, s[8:11], s5 offen
L_end_conv2_kernel:
    s_endpgm
.section .rodata,"a"
.p2align 6
.amdhsa_kernel conv2_kernel
  .amdhsa_next_free_vgpr 216
  .amdhsa_next_free_sgpr 96
  .amdhsa_accum_offset 216
  .amdhsa_group_segment_fixed_size 0
  .amdhsa_kernarg_size 120
  .amdhsa_user_sgpr_count 2
  .amdhsa_user_sgpr_kernarg_segment_ptr 1
  .amdhsa_system_sgpr_workgroup_id_x 1
.end_amdhsa_kernel
.text

.globl qkv1_kernel
.p2align 8
.type qkv1_kernel,@function
qkv1_kernel:
    s_cmp_ge_u32 s2, 256
    s_cbranch_scc1 L_end_qkv1_kernel
    s_load_dwordx2 s[8:9], s[0:1], 112
    s_mov_b32 s10, 25165824
    s_mov_b32 s11, 0x00020000
    s_mov_b32 s20, 0x05040100
    s_mov_b32 s21, 0x07060302
    v_lshrrev_b32 v1, 6, v0
    v_and_b32 v2, 63, v0
    v_and_b32 v3, 15, v2
    v_lshrrev_b32 v4, 4, v2
    s_nop 0
    v_readfirstlane_b32 s4, v1
    s_bfe_u32 s5, s2, 0x20001
    s_lshl_b32 s5, s5, 3
    s_lshr_b32 s6, s2, 5
    s_add_u32 s5, s5, s6
    s_and_b32 s6, s2, 1
    s_lshl_b32 s6, s6, 2
    s_bfe_u32 s7, s2, 0x20003
    s_add_u32 s6, s6, s7
    s_lshl_b32 s6, s6, 2
    s_add_u32 s6, s6, s4
    s_lshl_b32 s7, s6, 14
    s_add_u32 s7, s7, 13631488
    s_lshl_b32 s16, s5, 7
    s_add_u32 s16, s16, 2097152
    s_waitcnt lgkmcnt(0)
    v_and_b32 v5, 7, v0
    v_lshrrev_b32 v6, 3, v0
    v_lshlrev_b32 v7, 15, v6
    v_lshl_add_u32 v7, v5, 4, v7
    v_add_u32 v8, 0x100000, v7
    buffer_load_dwordx4 v[16:19], v7, s[8:11], s16 offen
    buffer_load_dwordx4 v[48:51], v8, s[8:11], s16 offen
    v_add_u32 v7, 4096, v7
    v_add_u32 v8, 4096, v8
    buffer_load_dwordx4 v[20:23], v7, s[8:11], s16 offen
    buffer_load_dwordx4 v[52:55], v8, s[8:11], s16 offen
    v_add_u32 v7, 4096, v7
    v_add_u32 v8, 4096, v8
    buffer_load_dwordx4 v[24:27], v7, s[8:11], s16 offen
    buffer_load_dwordx4 v[56:59], v8, s[8:11], s16 offen
    v_add_u32 v7, 4096, v7
    v_add_u32 v8, 4096, v8
    buffer_load_dwordx4 v[28:31], v7, s[8:11], s16 offen
    buffer_load_dwordx4 v[60:63], v8, s[8:11], s16 offen
    v_add_u32 v7, 4096, v7
    v_add_u32 v8, 4096, v8
    buffer_load_dwordx4 v[32:35], v7, s[8:11], s16 offen
    buffer_load_dwordx4 v[64:67], v8, s[8:11], s16 offen
    v_add_u32 v7, 4096, v7
    v_add_u32 v8, 4096, v8
    buffer_load_dwordx4 v[36:39], v7, s[8:11], s16 offen
    buffer_load_dwordx4 v[68:71], v8, s[8:11], s16 offen
    v_add_u32 v7, 4096, v7
    v_add_u32 v8, 4096, v8
    buffer_load_dwordx4 v[40:43], v7, s[8:11], s16 offen
    buffer_load_dwordx4 v[72:75], v8, s[8:11], s16 offen
    v_add_u32 v7, 4096, v7
    v_add_u32 v8, 4096, v8
    buffer_load_dwordx4 v[44:47], v7, s[8:11], s16 offen
    buffer_load_dwordx4 v[76:79], v8, s[8:11], s16 offen
    v_add_u32 v7, 4096, v7
    v_add_u32 v8, 4096, v8
    v_lshlrev_b32 v9, 4, v2
    s_add_u32 s26, s7, 0x80000
    s_add_u32 s27, s7, 0x100000
    buffer_load_dwordx4 a[0:3], v9, s[8:11], s7 offen offset:0
    buffer_load_dwordx4 a[64:67], v9, s[8:11], s26 offen offset:0
    buffer_load_dwordx4 a[128:131], v9, s[8:11], s27 offen offset:0
    buffer_load_dwordx4 a[4:7], v9, s[8:11], s7 offen offset:1024
    buffer_load_dwordx4 a[68:71], v9, s[8:11], s26 offen offset:1024
    buffer_load_dwordx4 a[132:135], v9, s[8:11], s27 offen offset:1024
    buffer_load_dwordx4 a[8:11], v9, s[8:11], s7 offen offset:2048
    buffer_load_dwordx4 a[72:75], v9, s[8:11], s26 offen offset:2048
    buffer_load_dwordx4 a[136:139], v9, s[8:11], s27 offen offset:2048
    v_lshrrev_b32 v10, 3, v3
    v_xor_b32 v10, v10, v3
    v_xor_b32 v10, v10, v4
    v_lshlrev_b32 v8, 1, v1
    v_xor_b32 v8, v8, v10
    v_lshlrev_b32 v7, 10, v3
    v_lshl_add_u32 v7, v1, 14, v7
    v_xor_b32 v11, 0, v10
    v_lshlrev_b32 v11, 4, v11
    v_lshl_add_u32 v12, v3, 10, v11
    v_xor_b32 v11, 2, v10
    v_lshlrev_b32 v11, 4, v11
    v_lshl_add_u32 v188, v3, 10, v11
    v_xor_b32 v11, 0, v8
    v_lshl_add_u32 v184, v11, 4, v7
    v_xor_b32 v11, 4, v10
    v_lshlrev_b32 v11, 4, v11
    v_lshl_add_u32 v13, v3, 10, v11
    v_xor_b32 v11, 6, v10
    v_lshlrev_b32 v11, 4, v11
    v_lshl_add_u32 v189, v3, 10, v11
    v_xor_b32 v11, 4, v8
    v_lshl_add_u32 v185, v11, 4, v7
    v_xor_b32 v11, 8, v10
    v_lshlrev_b32 v11, 4, v11
    v_lshl_add_u32 v14, v3, 10, v11
    v_xor_b32 v11, 10, v10
    v_lshlrev_b32 v11, 4, v11
    v_lshl_add_u32 v190, v3, 10, v11
    v_xor_b32 v11, 8, v8
    v_lshl_add_u32 v186, v11, 4, v7
    v_xor_b32 v11, 12, v10
    v_lshlrev_b32 v11, 4, v11
    v_lshl_add_u32 v15, v3, 10, v11
    v_xor_b32 v11, 14, v10
    v_lshlrev_b32 v11, 4, v11
    v_lshl_add_u32 v191, v3, 10, v11
    v_xor_b32 v11, 12, v8
    v_lshl_add_u32 v187, v11, 4, v7
    v_and_b32 v10, 1, v5
    v_lshlrev_b32 v10, 3, v10
    v_xor_b32 v10, v10, v5
    v_xor_b32 v10, v10, v6
    v_lshlrev_b32 v10, 4, v10
    v_lshl_add_u32 v7, v5, 13, v10
    s_mul_i32 s28, s6, 3072
    s_add_u32 s28, s28, 8912896
    v_mov_b32 v112, 0
    v_mov_b32 v113, 0
    v_mov_b32 v114, 0
    v_mov_b32 v115, 0
    v_mov_b32 v116, 0
    v_mov_b32 v117, 0
    v_mov_b32 v118, 0
    v_mov_b32 v119, 0
    v_mov_b32 v120, 0
    v_mov_b32 v121, 0
    v_mov_b32 v122, 0
    v_mov_b32 v123, 0
    v_mov_b32 v124, 0
    v_mov_b32 v125, 0
    v_mov_b32 v126, 0
    v_mov_b32 v127, 0
    v_mov_b32 v128, 0
    v_mov_b32 v129, 0
    v_mov_b32 v130, 0
    v_mov_b32 v131, 0
    v_mov_b32 v132, 0
    v_mov_b32 v133, 0
    v_mov_b32 v134, 0
    v_mov_b32 v135, 0
    v_mov_b32 v136, 0
    v_mov_b32 v137, 0
    v_mov_b32 v138, 0
    v_mov_b32 v139, 0
    v_mov_b32 v140, 0
    v_mov_b32 v141, 0
    v_mov_b32 v142, 0
    v_mov_b32 v143, 0
    v_mov_b32 v144, 0
    v_mov_b32 v145, 0
    v_mov_b32 v146, 0
    v_mov_b32 v147, 0
    v_mov_b32 v148, 0
    v_mov_b32 v149, 0
    v_mov_b32 v150, 0
    v_mov_b32 v151, 0
    v_mov_b32 v152, 0
    v_mov_b32 v153, 0
    v_mov_b32 v154, 0
    v_mov_b32 v155, 0
    v_mov_b32 v156, 0
    v_mov_b32 v157, 0
    v_mov_b32 v158, 0
    v_mov_b32 v159, 0
    v_mov_b32 v160, 0
    v_mov_b32 v161, 0
    v_mov_b32 v162, 0
    v_mov_b32 v163, 0
    v_mov_b32 v164, 0
    v_mov_b32 v165, 0
    v_mov_b32 v166, 0
    v_mov_b32 v167, 0
    v_mov_b32 v168, 0
    v_mov_b32 v169, 0
    v_mov_b32 v170, 0
    v_mov_b32 v171, 0
    v_mov_b32 v172, 0
    v_mov_b32 v173, 0
    v_mov_b32 v174, 0
    v_mov_b32 v175, 0
    v_mov_b32 v176, 0
    v_mov_b32 v177, 0
    v_mov_b32 v178, 0
    v_mov_b32 v179, 0
    v_mov_b32 v180, 0x3f803f80
    v_mov_b32 v181, 0x3f803f80
    v_mov_b32 v182, 0x3f803f80
    v_mov_b32 v183, 0x3f803f80
    s_waitcnt vmcnt(9)
    v_perm_b32 v80, v20, v16, s20
    v_perm_b32 v81, v28, v24, s20
    v_perm_b32 v82, v36, v32, s20
    v_perm_b32 v83, v44, v40, s20
    v_perm_b32 v84, v20, v16, s21
    v_perm_b32 v85, v28, v24, s21
    v_perm_b32 v86, v36, v32, s21
    v_perm_b32 v87, v44, v40, s21
    v_perm_b32 v88, v21, v17, s20
    v_perm_b32 v89, v29, v25, s20
    v_perm_b32 v90, v37, v33, s20
    v_perm_b32 v91, v45, v41, s20
    v_perm_b32 v92, v21, v17, s21
    v_perm_b32 v93, v29, v25, s21
    v_perm_b32 v94, v37, v33, s21
    v_perm_b32 v95, v45, v41, s21
    v_perm_b32 v96, v22, v18, s20
    v_perm_b32 v97, v30, v26, s20
    v_perm_b32 v98, v38, v34, s20
    v_perm_b32 v99, v46, v42, s20
    v_perm_b32 v100, v22, v18, s21
    v_perm_b32 v101, v30, v26, s21
    v_perm_b32 v102, v38, v34, s21
    v_perm_b32 v103, v46, v42, s21
    v_perm_b32 v104, v23, v19, s20
    v_perm_b32 v105, v31, v27, s20
    v_perm_b32 v106, v39, v35, s20
    v_perm_b32 v107, v47, v43, s20
    v_perm_b32 v108, v23, v19, s21
    v_perm_b32 v109, v31, v27, s21
    v_perm_b32 v110, v39, v35, s21
    v_perm_b32 v111, v47, v43, s21
    v_xor_b32 v10, 0, v7
    ds_write_b128 v10, v[80:83] offset:0
    buffer_load_dwordx4 a[12:15], v9, s[8:11], s7 offen offset:3072
    v_xor_b32 v11, 16, v7
    ds_write_b128 v11, v[84:87] offset:1024
    buffer_load_dwordx4 a[76:79], v9, s[8:11], s26 offen offset:3072
    v_xor_b32 v10, 32, v7
    ds_write_b128 v10, v[88:91] offset:2048
    buffer_load_dwordx4 a[140:143], v9, s[8:11], s27 offen offset:3072
    v_add_u32 v9, 4096, v9
    v_xor_b32 v11, 48, v7
    ds_write_b128 v11, v[92:95] offset:3072
    buffer_load_dwordx4 a[16:19], v9, s[8:11], s7 offen offset:0
    v_xor_b32 v10, 64, v7
    ds_write_b128 v10, v[96:99] offset:4096
    buffer_load_dwordx4 a[80:83], v9, s[8:11], s26 offen offset:0
    v_xor_b32 v11, 80, v7
    ds_write_b128 v11, v[100:103] offset:5120
    buffer_load_dwordx4 a[144:147], v9, s[8:11], s27 offen offset:0
    v_xor_b32 v10, 96, v7
    ds_write_b128 v10, v[104:107] offset:6144
    v_xor_b32 v11, 112, v7
    ds_write_b128 v11, v[108:111] offset:7168
    v_perm_b32 v80, v52, v48, s20
    v_perm_b32 v81, v60, v56, s20
    v_perm_b32 v82, v68, v64, s20
    v_perm_b32 v83, v76, v72, s20
    v_perm_b32 v84, v52, v48, s21
    v_perm_b32 v85, v60, v56, s21
    v_perm_b32 v86, v68, v64, s21
    v_perm_b32 v87, v76, v72, s21
    v_perm_b32 v88, v53, v49, s20
    v_perm_b32 v89, v61, v57, s20
    v_perm_b32 v90, v69, v65, s20
    v_perm_b32 v91, v77, v73, s20
    v_perm_b32 v92, v53, v49, s21
    v_perm_b32 v93, v61, v57, s21
    v_perm_b32 v94, v69, v65, s21
    v_perm_b32 v95, v77, v73, s21
    v_perm_b32 v96, v54, v50, s20
    v_perm_b32 v97, v62, v58, s20
    v_perm_b32 v98, v70, v66, s20
    v_perm_b32 v99, v78, v74, s20
    v_perm_b32 v100, v54, v50, s21
    v_perm_b32 v101, v62, v58, s21
    v_perm_b32 v102, v70, v66, s21
    v_perm_b32 v103, v78, v74, s21
    v_perm_b32 v104, v55, v51, s20
    v_perm_b32 v105, v63, v59, s20
    v_perm_b32 v106, v71, v67, s20
    v_perm_b32 v107, v79, v75, s20
    v_perm_b32 v108, v55, v51, s21
    v_perm_b32 v109, v63, v59, s21
    v_perm_b32 v110, v71, v67, s21
    v_perm_b32 v111, v79, v75, s21
    v_xor_b32 v10, 0, v7
    ds_write_b128 v10, v[80:83] offset:512
    buffer_load_dwordx4 a[20:23], v9, s[8:11], s7 offen offset:1024
    v_xor_b32 v11, 16, v7
    ds_write_b128 v11, v[84:87] offset:1536
    buffer_load_dwordx4 a[84:87], v9, s[8:11], s26 offen offset:1024
    v_xor_b32 v10, 32, v7
    ds_write_b128 v10, v[88:91] offset:2560
    buffer_load_dwordx4 a[148:151], v9, s[8:11], s27 offen offset:1024
    v_xor_b32 v11, 48, v7
    ds_write_b128 v11, v[92:95] offset:3584
    buffer_load_dwordx4 a[24:27], v9, s[8:11], s7 offen offset:2048
    v_xor_b32 v10, 64, v7
    ds_write_b128 v10, v[96:99] offset:4608
    buffer_load_dwordx4 a[88:91], v9, s[8:11], s26 offen offset:2048
    v_xor_b32 v11, 80, v7
    ds_write_b128 v11, v[100:103] offset:5632
    buffer_load_dwordx4 a[152:155], v9, s[8:11], s27 offen offset:2048
    v_xor_b32 v10, 96, v7
    ds_write_b128 v10, v[104:107] offset:6656
    v_xor_b32 v11, 112, v7
    ds_write_b128 v11, v[108:111] offset:7680
    s_waitcnt lgkmcnt(0)
    s_barrier
    ds_read_b128 v[16:19], v12 offset:0
    ds_read_b128 v[20:23], v188 offset:16384
    ds_read_b128 v[24:27], v13 offset:32768
    ds_read_b128 v[28:31], v189 offset:49152
    ds_read_b128 v[32:35], v184 offset:0
    ds_read_b128 v[36:39], v13 offset:0
    ds_read_b128 v[40:43], v189 offset:16384
    ds_read_b128 v[44:47], v12 offset:32768
    ds_read_b128 v[48:51], v188 offset:49152
    ds_read_b128 v[52:55], v185 offset:0
    buffer_load_dwordx4 a[28:31], v9, s[8:11], s7 offen offset:3072
    buffer_load_dwordx4 a[92:95], v9, s[8:11], s26 offen offset:3072
    buffer_load_dwordx4 a[156:159], v9, s[8:11], s27 offen offset:3072
    v_add_u32 v9, 4096, v9
    s_waitcnt vmcnt(21) lgkmcnt(5)
    v_mfma_f32_16x16x32_bf16 v[112:115], a[0:3], v[16:19], v[112:115]
    v_mfma_f32_16x16x32_bf16 v[116:119], a[0:3], v[20:23], v[116:119]
    v_mfma_f32_16x16x32_bf16 v[120:123], a[0:3], v[24:27], v[120:123]
    v_mfma_f32_16x16x32_bf16 v[124:127], a[0:3], v[28:31], v[124:127]
    v_mfma_f32_16x16x32_bf16 v[160:163], a[0:3], v[180:183], v[160:163]
    v_mfma_f32_16x16x32_bf16 v[128:131], a[64:67], v[16:19], v[128:131]
    v_mfma_f32_16x16x32_bf16 v[132:135], a[64:67], v[20:23], v[132:135]
    v_mfma_f32_16x16x32_bf16 v[136:139], a[64:67], v[24:27], v[136:139]
    v_mfma_f32_16x16x32_bf16 v[140:143], a[64:67], v[28:31], v[140:143]
    v_mfma_f32_16x16x32_bf16 v[164:167], a[64:67], v[180:183], v[164:167]
    v_mfma_f32_16x16x32_bf16 v[144:147], v[16:19], a[128:131], v[144:147]
    v_mfma_f32_16x16x32_bf16 v[148:151], v[20:23], a[128:131], v[148:151]
    v_mfma_f32_16x16x32_bf16 v[152:155], v[24:27], a[128:131], v[152:155]
    v_mfma_f32_16x16x32_bf16 v[156:159], v[28:31], a[128:131], v[156:159]
    v_mfma_f32_16x16x32_bf16 v[168:171], v[180:183], a[128:131], v[168:171]
    v_mfma_f32_16x16x32_bf16 v[172:175], v[32:35], v[32:35], v[172:175]
    v_mfma_f32_16x16x32_bf16 v[176:179], v[32:35], v[180:183], v[176:179]
    ds_read_b128 v[16:19], v14 offset:0
    ds_read_b128 v[20:23], v190 offset:16384
    ds_read_b128 v[24:27], v15 offset:32768
    ds_read_b128 v[28:31], v191 offset:49152
    ds_read_b128 v[32:35], v186 offset:0
    buffer_load_dwordx4 a[32:35], v9, s[8:11], s7 offen offset:0
    buffer_load_dwordx4 a[96:99], v9, s[8:11], s26 offen offset:0
    buffer_load_dwordx4 a[160:163], v9, s[8:11], s27 offen offset:0
    s_waitcnt vmcnt(21) lgkmcnt(5)
    v_mfma_f32_16x16x32_bf16 v[112:115], a[4:7], v[36:39], v[112:115]
    v_mfma_f32_16x16x32_bf16 v[116:119], a[4:7], v[40:43], v[116:119]
    v_mfma_f32_16x16x32_bf16 v[120:123], a[4:7], v[44:47], v[120:123]
    v_mfma_f32_16x16x32_bf16 v[124:127], a[4:7], v[48:51], v[124:127]
    v_mfma_f32_16x16x32_bf16 v[160:163], a[4:7], v[180:183], v[160:163]
    v_mfma_f32_16x16x32_bf16 v[128:131], a[68:71], v[36:39], v[128:131]
    v_mfma_f32_16x16x32_bf16 v[132:135], a[68:71], v[40:43], v[132:135]
    v_mfma_f32_16x16x32_bf16 v[136:139], a[68:71], v[44:47], v[136:139]
    v_mfma_f32_16x16x32_bf16 v[140:143], a[68:71], v[48:51], v[140:143]
    v_mfma_f32_16x16x32_bf16 v[164:167], a[68:71], v[180:183], v[164:167]
    v_mfma_f32_16x16x32_bf16 v[144:147], v[36:39], a[132:135], v[144:147]
    v_mfma_f32_16x16x32_bf16 v[148:151], v[40:43], a[132:135], v[148:151]
    v_mfma_f32_16x16x32_bf16 v[152:155], v[44:47], a[132:135], v[152:155]
    v_mfma_f32_16x16x32_bf16 v[156:159], v[48:51], a[132:135], v[156:159]
    v_mfma_f32_16x16x32_bf16 v[168:171], v[180:183], a[132:135], v[168:171]
    v_mfma_f32_16x16x32_bf16 v[172:175], v[52:55], v[52:55], v[172:175]
    v_mfma_f32_16x16x32_bf16 v[176:179], v[52:55], v[180:183], v[176:179]
    ds_read_b128 v[36:39], v15 offset:0
    ds_read_b128 v[40:43], v191 offset:16384
    ds_read_b128 v[44:47], v14 offset:32768
    ds_read_b128 v[48:51], v190 offset:49152
    ds_read_b128 v[52:55], v187 offset:0
    buffer_load_dwordx4 a[36:39], v9, s[8:11], s7 offen offset:1024
    buffer_load_dwordx4 a[100:103], v9, s[8:11], s26 offen offset:1024
    buffer_load_dwordx4 a[164:167], v9, s[8:11], s27 offen offset:1024
    s_waitcnt vmcnt(21) lgkmcnt(5)
    v_mfma_f32_16x16x32_bf16 v[112:115], a[8:11], v[16:19], v[112:115]
    v_mfma_f32_16x16x32_bf16 v[116:119], a[8:11], v[20:23], v[116:119]
    v_mfma_f32_16x16x32_bf16 v[120:123], a[8:11], v[24:27], v[120:123]
    v_mfma_f32_16x16x32_bf16 v[124:127], a[8:11], v[28:31], v[124:127]
    v_mfma_f32_16x16x32_bf16 v[160:163], a[8:11], v[180:183], v[160:163]
    v_mfma_f32_16x16x32_bf16 v[128:131], a[72:75], v[16:19], v[128:131]
    v_mfma_f32_16x16x32_bf16 v[132:135], a[72:75], v[20:23], v[132:135]
    v_mfma_f32_16x16x32_bf16 v[136:139], a[72:75], v[24:27], v[136:139]
    v_mfma_f32_16x16x32_bf16 v[140:143], a[72:75], v[28:31], v[140:143]
    v_mfma_f32_16x16x32_bf16 v[164:167], a[72:75], v[180:183], v[164:167]
    v_mfma_f32_16x16x32_bf16 v[144:147], v[16:19], a[136:139], v[144:147]
    v_mfma_f32_16x16x32_bf16 v[148:151], v[20:23], a[136:139], v[148:151]
    v_mfma_f32_16x16x32_bf16 v[152:155], v[24:27], a[136:139], v[152:155]
    v_mfma_f32_16x16x32_bf16 v[156:159], v[28:31], a[136:139], v[156:159]
    v_mfma_f32_16x16x32_bf16 v[168:171], v[180:183], a[136:139], v[168:171]
    v_mfma_f32_16x16x32_bf16 v[172:175], v[32:35], v[32:35], v[172:175]
    v_mfma_f32_16x16x32_bf16 v[176:179], v[32:35], v[180:183], v[176:179]
    ds_read_b128 v[16:19], v12 offset:256
    ds_read_b128 v[20:23], v188 offset:16640
    ds_read_b128 v[24:27], v13 offset:33024
    ds_read_b128 v[28:31], v189 offset:49408
    ds_read_b128 v[32:35], v184 offset:256
    buffer_load_dwordx4 a[40:43], v9, s[8:11], s7 offen offset:2048
    buffer_load_dwordx4 a[104:107], v9, s[8:11], s26 offen offset:2048
    buffer_load_dwordx4 a[168:171], v9, s[8:11], s27 offen offset:2048
    s_waitcnt vmcnt(21) lgkmcnt(5)
    v_mfma_f32_16x16x32_bf16 v[112:115], a[12:15], v[36:39], v[112:115]
    v_mfma_f32_16x16x32_bf16 v[116:119], a[12:15], v[40:43], v[116:119]
    v_mfma_f32_16x16x32_bf16 v[120:123], a[12:15], v[44:47], v[120:123]
    v_mfma_f32_16x16x32_bf16 v[124:127], a[12:15], v[48:51], v[124:127]
    v_mfma_f32_16x16x32_bf16 v[160:163], a[12:15], v[180:183], v[160:163]
    v_mfma_f32_16x16x32_bf16 v[128:131], a[76:79], v[36:39], v[128:131]
    v_mfma_f32_16x16x32_bf16 v[132:135], a[76:79], v[40:43], v[132:135]
    v_mfma_f32_16x16x32_bf16 v[136:139], a[76:79], v[44:47], v[136:139]
    v_mfma_f32_16x16x32_bf16 v[140:143], a[76:79], v[48:51], v[140:143]
    v_mfma_f32_16x16x32_bf16 v[164:167], a[76:79], v[180:183], v[164:167]
    v_mfma_f32_16x16x32_bf16 v[144:147], v[36:39], a[140:143], v[144:147]
    v_mfma_f32_16x16x32_bf16 v[148:151], v[40:43], a[140:143], v[148:151]
    v_mfma_f32_16x16x32_bf16 v[152:155], v[44:47], a[140:143], v[152:155]
    v_mfma_f32_16x16x32_bf16 v[156:159], v[48:51], a[140:143], v[156:159]
    v_mfma_f32_16x16x32_bf16 v[168:171], v[180:183], a[140:143], v[168:171]
    v_mfma_f32_16x16x32_bf16 v[172:175], v[52:55], v[52:55], v[172:175]
    v_mfma_f32_16x16x32_bf16 v[176:179], v[52:55], v[180:183], v[176:179]
    ds_read_b128 v[36:39], v13 offset:256
    ds_read_b128 v[40:43], v189 offset:16640
    ds_read_b128 v[44:47], v12 offset:33024
    ds_read_b128 v[48:51], v188 offset:49408
    ds_read_b128 v[52:55], v185 offset:256
    buffer_load_dwordx4 a[44:47], v9, s[8:11], s7 offen offset:3072
    buffer_load_dwordx4 a[108:111], v9, s[8:11], s26 offen offset:3072
    buffer_load_dwordx4 a[172:175], v9, s[8:11], s27 offen offset:3072
    v_add_u32 v9, 4096, v9
    s_waitcnt vmcnt(21) lgkmcnt(5)
    v_mfma_f32_16x16x32_bf16 v[112:115], a[16:19], v[16:19], v[112:115]
    v_mfma_f32_16x16x32_bf16 v[116:119], a[16:19], v[20:23], v[116:119]
    v_mfma_f32_16x16x32_bf16 v[120:123], a[16:19], v[24:27], v[120:123]
    v_mfma_f32_16x16x32_bf16 v[124:127], a[16:19], v[28:31], v[124:127]
    v_mfma_f32_16x16x32_bf16 v[160:163], a[16:19], v[180:183], v[160:163]
    v_mfma_f32_16x16x32_bf16 v[128:131], a[80:83], v[16:19], v[128:131]
    v_mfma_f32_16x16x32_bf16 v[132:135], a[80:83], v[20:23], v[132:135]
    v_mfma_f32_16x16x32_bf16 v[136:139], a[80:83], v[24:27], v[136:139]
    v_mfma_f32_16x16x32_bf16 v[140:143], a[80:83], v[28:31], v[140:143]
    v_mfma_f32_16x16x32_bf16 v[164:167], a[80:83], v[180:183], v[164:167]
    v_mfma_f32_16x16x32_bf16 v[144:147], v[16:19], a[144:147], v[144:147]
    v_mfma_f32_16x16x32_bf16 v[148:151], v[20:23], a[144:147], v[148:151]
    v_mfma_f32_16x16x32_bf16 v[152:155], v[24:27], a[144:147], v[152:155]
    v_mfma_f32_16x16x32_bf16 v[156:159], v[28:31], a[144:147], v[156:159]
    v_mfma_f32_16x16x32_bf16 v[168:171], v[180:183], a[144:147], v[168:171]
    v_mfma_f32_16x16x32_bf16 v[172:175], v[32:35], v[32:35], v[172:175]
    v_mfma_f32_16x16x32_bf16 v[176:179], v[32:35], v[180:183], v[176:179]
    ds_read_b128 v[16:19], v14 offset:256
    ds_read_b128 v[20:23], v190 offset:16640
    ds_read_b128 v[24:27], v15 offset:33024
    ds_read_b128 v[28:31], v191 offset:49408
    ds_read_b128 v[32:35], v186 offset:256
    buffer_load_dwordx4 a[48:51], v9, s[8:11], s7 offen offset:0
    buffer_load_dwordx4 a[112:115], v9, s[8:11], s26 offen offset:0
    buffer_load_dwordx4 a[176:179], v9, s[8:11], s27 offen offset:0
    s_waitcnt vmcnt(21) lgkmcnt(5)
    v_mfma_f32_16x16x32_bf16 v[112:115], a[20:23], v[36:39], v[112:115]
    v_mfma_f32_16x16x32_bf16 v[116:119], a[20:23], v[40:43], v[116:119]
    v_mfma_f32_16x16x32_bf16 v[120:123], a[20:23], v[44:47], v[120:123]
    v_mfma_f32_16x16x32_bf16 v[124:127], a[20:23], v[48:51], v[124:127]
    v_mfma_f32_16x16x32_bf16 v[160:163], a[20:23], v[180:183], v[160:163]
    v_mfma_f32_16x16x32_bf16 v[128:131], a[84:87], v[36:39], v[128:131]
    v_mfma_f32_16x16x32_bf16 v[132:135], a[84:87], v[40:43], v[132:135]
    v_mfma_f32_16x16x32_bf16 v[136:139], a[84:87], v[44:47], v[136:139]
    v_mfma_f32_16x16x32_bf16 v[140:143], a[84:87], v[48:51], v[140:143]
    v_mfma_f32_16x16x32_bf16 v[164:167], a[84:87], v[180:183], v[164:167]
    v_mfma_f32_16x16x32_bf16 v[144:147], v[36:39], a[148:151], v[144:147]
    v_mfma_f32_16x16x32_bf16 v[148:151], v[40:43], a[148:151], v[148:151]
    v_mfma_f32_16x16x32_bf16 v[152:155], v[44:47], a[148:151], v[152:155]
    v_mfma_f32_16x16x32_bf16 v[156:159], v[48:51], a[148:151], v[156:159]
    v_mfma_f32_16x16x32_bf16 v[168:171], v[180:183], a[148:151], v[168:171]
    v_mfma_f32_16x16x32_bf16 v[172:175], v[52:55], v[52:55], v[172:175]
    v_mfma_f32_16x16x32_bf16 v[176:179], v[52:55], v[180:183], v[176:179]
    ds_read_b128 v[36:39], v15 offset:256
    ds_read_b128 v[40:43], v191 offset:16640
    ds_read_b128 v[44:47], v14 offset:33024
    ds_read_b128 v[48:51], v190 offset:49408
    ds_read_b128 v[52:55], v187 offset:256
    buffer_load_dwordx4 a[52:55], v9, s[8:11], s7 offen offset:1024
    buffer_load_dwordx4 a[116:119], v9, s[8:11], s26 offen offset:1024
    buffer_load_dwordx4 a[180:183], v9, s[8:11], s27 offen offset:1024
    s_waitcnt vmcnt(21) lgkmcnt(5)
    v_mfma_f32_16x16x32_bf16 v[112:115], a[24:27], v[16:19], v[112:115]
    v_mfma_f32_16x16x32_bf16 v[116:119], a[24:27], v[20:23], v[116:119]
    v_mfma_f32_16x16x32_bf16 v[120:123], a[24:27], v[24:27], v[120:123]
    v_mfma_f32_16x16x32_bf16 v[124:127], a[24:27], v[28:31], v[124:127]
    v_mfma_f32_16x16x32_bf16 v[160:163], a[24:27], v[180:183], v[160:163]
    v_mfma_f32_16x16x32_bf16 v[128:131], a[88:91], v[16:19], v[128:131]
    v_mfma_f32_16x16x32_bf16 v[132:135], a[88:91], v[20:23], v[132:135]
    v_mfma_f32_16x16x32_bf16 v[136:139], a[88:91], v[24:27], v[136:139]
    v_mfma_f32_16x16x32_bf16 v[140:143], a[88:91], v[28:31], v[140:143]
    v_mfma_f32_16x16x32_bf16 v[164:167], a[88:91], v[180:183], v[164:167]
    v_mfma_f32_16x16x32_bf16 v[144:147], v[16:19], a[152:155], v[144:147]
    v_mfma_f32_16x16x32_bf16 v[148:151], v[20:23], a[152:155], v[148:151]
    v_mfma_f32_16x16x32_bf16 v[152:155], v[24:27], a[152:155], v[152:155]
    v_mfma_f32_16x16x32_bf16 v[156:159], v[28:31], a[152:155], v[156:159]
    v_mfma_f32_16x16x32_bf16 v[168:171], v[180:183], a[152:155], v[168:171]
    v_mfma_f32_16x16x32_bf16 v[172:175], v[32:35], v[32:35], v[172:175]
    v_mfma_f32_16x16x32_bf16 v[176:179], v[32:35], v[180:183], v[176:179]
    ds_read_b128 v[16:19], v12 offset:512
    ds_read_b128 v[20:23], v188 offset:16896
    ds_read_b128 v[24:27], v13 offset:33280
    ds_read_b128 v[28:31], v189 offset:49664
    ds_read_b128 v[32:35], v184 offset:512
    buffer_load_dwordx4 a[56:59], v9, s[8:11], s7 offen offset:2048
    buffer_load_dwordx4 a[120:123], v9, s[8:11], s26 offen offset:2048
    buffer_load_dwordx4 a[184:187], v9, s[8:11], s27 offen offset:2048
    s_waitcnt vmcnt(21) lgkmcnt(5)
    v_mfma_f32_16x16x32_bf16 v[112:115], a[28:31], v[36:39], v[112:115]
    v_mfma_f32_16x16x32_bf16 v[116:119], a[28:31], v[40:43], v[116:119]
    v_mfma_f32_16x16x32_bf16 v[120:123], a[28:31], v[44:47], v[120:123]
    v_mfma_f32_16x16x32_bf16 v[124:127], a[28:31], v[48:51], v[124:127]
    v_mfma_f32_16x16x32_bf16 v[160:163], a[28:31], v[180:183], v[160:163]
    v_mfma_f32_16x16x32_bf16 v[128:131], a[92:95], v[36:39], v[128:131]
    v_mfma_f32_16x16x32_bf16 v[132:135], a[92:95], v[40:43], v[132:135]
    v_mfma_f32_16x16x32_bf16 v[136:139], a[92:95], v[44:47], v[136:139]
    v_mfma_f32_16x16x32_bf16 v[140:143], a[92:95], v[48:51], v[140:143]
    v_mfma_f32_16x16x32_bf16 v[164:167], a[92:95], v[180:183], v[164:167]
    v_mfma_f32_16x16x32_bf16 v[144:147], v[36:39], a[156:159], v[144:147]
    v_mfma_f32_16x16x32_bf16 v[148:151], v[40:43], a[156:159], v[148:151]
    v_mfma_f32_16x16x32_bf16 v[152:155], v[44:47], a[156:159], v[152:155]
    v_mfma_f32_16x16x32_bf16 v[156:159], v[48:51], a[156:159], v[156:159]
    v_mfma_f32_16x16x32_bf16 v[168:171], v[180:183], a[156:159], v[168:171]
    v_mfma_f32_16x16x32_bf16 v[172:175], v[52:55], v[52:55], v[172:175]
    v_mfma_f32_16x16x32_bf16 v[176:179], v[52:55], v[180:183], v[176:179]
    ds_read_b128 v[36:39], v13 offset:512
    ds_read_b128 v[40:43], v189 offset:16896
    ds_read_b128 v[44:47], v12 offset:33280
    ds_read_b128 v[48:51], v188 offset:49664
    ds_read_b128 v[52:55], v185 offset:512
    buffer_load_dwordx4 a[60:63], v9, s[8:11], s7 offen offset:3072
    buffer_load_dwordx4 a[124:127], v9, s[8:11], s26 offen offset:3072
    buffer_load_dwordx4 a[188:191], v9, s[8:11], s27 offen offset:3072
    v_add_u32 v9, 4096, v9
    s_waitcnt vmcnt(21) lgkmcnt(5)
    v_mfma_f32_16x16x32_bf16 v[112:115], a[32:35], v[16:19], v[112:115]
    v_mfma_f32_16x16x32_bf16 v[116:119], a[32:35], v[20:23], v[116:119]
    v_mfma_f32_16x16x32_bf16 v[120:123], a[32:35], v[24:27], v[120:123]
    v_mfma_f32_16x16x32_bf16 v[124:127], a[32:35], v[28:31], v[124:127]
    v_mfma_f32_16x16x32_bf16 v[160:163], a[32:35], v[180:183], v[160:163]
    v_mfma_f32_16x16x32_bf16 v[128:131], a[96:99], v[16:19], v[128:131]
    v_mfma_f32_16x16x32_bf16 v[132:135], a[96:99], v[20:23], v[132:135]
    v_mfma_f32_16x16x32_bf16 v[136:139], a[96:99], v[24:27], v[136:139]
    v_mfma_f32_16x16x32_bf16 v[140:143], a[96:99], v[28:31], v[140:143]
    v_mfma_f32_16x16x32_bf16 v[164:167], a[96:99], v[180:183], v[164:167]
    v_mfma_f32_16x16x32_bf16 v[144:147], v[16:19], a[160:163], v[144:147]
    v_mfma_f32_16x16x32_bf16 v[148:151], v[20:23], a[160:163], v[148:151]
    v_mfma_f32_16x16x32_bf16 v[152:155], v[24:27], a[160:163], v[152:155]
    v_mfma_f32_16x16x32_bf16 v[156:159], v[28:31], a[160:163], v[156:159]
    v_mfma_f32_16x16x32_bf16 v[168:171], v[180:183], a[160:163], v[168:171]
    v_mfma_f32_16x16x32_bf16 v[172:175], v[32:35], v[32:35], v[172:175]
    v_mfma_f32_16x16x32_bf16 v[176:179], v[32:35], v[180:183], v[176:179]
    ds_read_b128 v[16:19], v14 offset:512
    ds_read_b128 v[20:23], v190 offset:16896
    ds_read_b128 v[24:27], v15 offset:33280
    ds_read_b128 v[28:31], v191 offset:49664
    ds_read_b128 v[32:35], v186 offset:512
    s_waitcnt vmcnt(18) lgkmcnt(5)
    v_mfma_f32_16x16x32_bf16 v[112:115], a[36:39], v[36:39], v[112:115]
    v_mfma_f32_16x16x32_bf16 v[116:119], a[36:39], v[40:43], v[116:119]
    v_mfma_f32_16x16x32_bf16 v[120:123], a[36:39], v[44:47], v[120:123]
    v_mfma_f32_16x16x32_bf16 v[124:127], a[36:39], v[48:51], v[124:127]
    v_mfma_f32_16x16x32_bf16 v[160:163], a[36:39], v[180:183], v[160:163]
    v_mfma_f32_16x16x32_bf16 v[128:131], a[100:103], v[36:39], v[128:131]
    v_mfma_f32_16x16x32_bf16 v[132:135], a[100:103], v[40:43], v[132:135]
    v_mfma_f32_16x16x32_bf16 v[136:139], a[100:103], v[44:47], v[136:139]
    v_mfma_f32_16x16x32_bf16 v[140:143], a[100:103], v[48:51], v[140:143]
    v_mfma_f32_16x16x32_bf16 v[164:167], a[100:103], v[180:183], v[164:167]
    v_mfma_f32_16x16x32_bf16 v[144:147], v[36:39], a[164:167], v[144:147]
    v_mfma_f32_16x16x32_bf16 v[148:151], v[40:43], a[164:167], v[148:151]
    v_mfma_f32_16x16x32_bf16 v[152:155], v[44:47], a[164:167], v[152:155]
    v_mfma_f32_16x16x32_bf16 v[156:159], v[48:51], a[164:167], v[156:159]
    v_mfma_f32_16x16x32_bf16 v[168:171], v[180:183], a[164:167], v[168:171]
    v_mfma_f32_16x16x32_bf16 v[172:175], v[52:55], v[52:55], v[172:175]
    v_mfma_f32_16x16x32_bf16 v[176:179], v[52:55], v[180:183], v[176:179]
    ds_read_b128 v[36:39], v15 offset:512
    ds_read_b128 v[40:43], v191 offset:16896
    ds_read_b128 v[44:47], v14 offset:33280
    ds_read_b128 v[48:51], v190 offset:49664
    ds_read_b128 v[52:55], v187 offset:512
    s_waitcnt vmcnt(15) lgkmcnt(5)
    v_mfma_f32_16x16x32_bf16 v[112:115], a[40:43], v[16:19], v[112:115]
    v_mfma_f32_16x16x32_bf16 v[116:119], a[40:43], v[20:23], v[116:119]
    v_mfma_f32_16x16x32_bf16 v[120:123], a[40:43], v[24:27], v[120:123]
    v_mfma_f32_16x16x32_bf16 v[124:127], a[40:43], v[28:31], v[124:127]
    v_mfma_f32_16x16x32_bf16 v[160:163], a[40:43], v[180:183], v[160:163]
    v_mfma_f32_16x16x32_bf16 v[128:131], a[104:107], v[16:19], v[128:131]
    v_mfma_f32_16x16x32_bf16 v[132:135], a[104:107], v[20:23], v[132:135]
    v_mfma_f32_16x16x32_bf16 v[136:139], a[104:107], v[24:27], v[136:139]
    v_mfma_f32_16x16x32_bf16 v[140:143], a[104:107], v[28:31], v[140:143]
    v_mfma_f32_16x16x32_bf16 v[164:167], a[104:107], v[180:183], v[164:167]
    v_mfma_f32_16x16x32_bf16 v[144:147], v[16:19], a[168:171], v[144:147]
    v_mfma_f32_16x16x32_bf16 v[148:151], v[20:23], a[168:171], v[148:151]
    v_mfma_f32_16x16x32_bf16 v[152:155], v[24:27], a[168:171], v[152:155]
    v_mfma_f32_16x16x32_bf16 v[156:159], v[28:31], a[168:171], v[156:159]
    v_mfma_f32_16x16x32_bf16 v[168:171], v[180:183], a[168:171], v[168:171]
    v_mfma_f32_16x16x32_bf16 v[172:175], v[32:35], v[32:35], v[172:175]
    v_mfma_f32_16x16x32_bf16 v[176:179], v[32:35], v[180:183], v[176:179]
    ds_read_b128 v[16:19], v12 offset:768
    ds_read_b128 v[20:23], v188 offset:17152
    ds_read_b128 v[24:27], v13 offset:33536
    ds_read_b128 v[28:31], v189 offset:49920
    ds_read_b128 v[32:35], v184 offset:768
    s_waitcnt vmcnt(12) lgkmcnt(5)
    v_mfma_f32_16x16x32_bf16 v[112:115], a[44:47], v[36:39], v[112:115]
    v_mfma_f32_16x16x32_bf16 v[116:119], a[44:47], v[40:43], v[116:119]
    v_mfma_f32_16x16x32_bf16 v[120:123], a[44:47], v[44:47], v[120:123]
    v_mfma_f32_16x16x32_bf16 v[124:127], a[44:47], v[48:51], v[124:127]
    v_mfma_f32_16x16x32_bf16 v[160:163], a[44:47], v[180:183], v[160:163]
    v_mfma_f32_16x16x32_bf16 v[128:131], a[108:111], v[36:39], v[128:131]
    v_mfma_f32_16x16x32_bf16 v[132:135], a[108:111], v[40:43], v[132:135]
    v_mfma_f32_16x16x32_bf16 v[136:139], a[108:111], v[44:47], v[136:139]
    v_mfma_f32_16x16x32_bf16 v[140:143], a[108:111], v[48:51], v[140:143]
    v_mfma_f32_16x16x32_bf16 v[164:167], a[108:111], v[180:183], v[164:167]
    v_mfma_f32_16x16x32_bf16 v[144:147], v[36:39], a[172:175], v[144:147]
    v_mfma_f32_16x16x32_bf16 v[148:151], v[40:43], a[172:175], v[148:151]
    v_mfma_f32_16x16x32_bf16 v[152:155], v[44:47], a[172:175], v[152:155]
    v_mfma_f32_16x16x32_bf16 v[156:159], v[48:51], a[172:175], v[156:159]
    v_mfma_f32_16x16x32_bf16 v[168:171], v[180:183], a[172:175], v[168:171]
    v_mfma_f32_16x16x32_bf16 v[172:175], v[52:55], v[52:55], v[172:175]
    v_mfma_f32_16x16x32_bf16 v[176:179], v[52:55], v[180:183], v[176:179]
    ds_read_b128 v[36:39], v13 offset:768
    ds_read_b128 v[40:43], v189 offset:17152
    ds_read_b128 v[44:47], v12 offset:33536
    ds_read_b128 v[48:51], v188 offset:49920
    ds_read_b128 v[52:55], v185 offset:768
    s_waitcnt vmcnt(9) lgkmcnt(5)
    v_mfma_f32_16x16x32_bf16 v[112:115], a[48:51], v[16:19], v[112:115]
    v_mfma_f32_16x16x32_bf16 v[116:119], a[48:51], v[20:23], v[116:119]
    v_mfma_f32_16x16x32_bf16 v[120:123], a[48:51], v[24:27], v[120:123]
    v_mfma_f32_16x16x32_bf16 v[124:127], a[48:51], v[28:31], v[124:127]
    v_mfma_f32_16x16x32_bf16 v[160:163], a[48:51], v[180:183], v[160:163]
    v_mfma_f32_16x16x32_bf16 v[128:131], a[112:115], v[16:19], v[128:131]
    v_mfma_f32_16x16x32_bf16 v[132:135], a[112:115], v[20:23], v[132:135]
    v_mfma_f32_16x16x32_bf16 v[136:139], a[112:115], v[24:27], v[136:139]
    v_mfma_f32_16x16x32_bf16 v[140:143], a[112:115], v[28:31], v[140:143]
    v_mfma_f32_16x16x32_bf16 v[164:167], a[112:115], v[180:183], v[164:167]
    v_mfma_f32_16x16x32_bf16 v[144:147], v[16:19], a[176:179], v[144:147]
    v_mfma_f32_16x16x32_bf16 v[148:151], v[20:23], a[176:179], v[148:151]
    v_mfma_f32_16x16x32_bf16 v[152:155], v[24:27], a[176:179], v[152:155]
    v_mfma_f32_16x16x32_bf16 v[156:159], v[28:31], a[176:179], v[156:159]
    v_mfma_f32_16x16x32_bf16 v[168:171], v[180:183], a[176:179], v[168:171]
    v_mfma_f32_16x16x32_bf16 v[172:175], v[32:35], v[32:35], v[172:175]
    v_mfma_f32_16x16x32_bf16 v[176:179], v[32:35], v[180:183], v[176:179]
    ds_read_b128 v[16:19], v14 offset:768
    ds_read_b128 v[20:23], v190 offset:17152
    ds_read_b128 v[24:27], v15 offset:33536
    ds_read_b128 v[28:31], v191 offset:49920
    ds_read_b128 v[32:35], v186 offset:768
    s_waitcnt vmcnt(6) lgkmcnt(5)
    v_mfma_f32_16x16x32_bf16 v[112:115], a[52:55], v[36:39], v[112:115]
    v_mfma_f32_16x16x32_bf16 v[116:119], a[52:55], v[40:43], v[116:119]
    v_mfma_f32_16x16x32_bf16 v[120:123], a[52:55], v[44:47], v[120:123]
    v_mfma_f32_16x16x32_bf16 v[124:127], a[52:55], v[48:51], v[124:127]
    v_mfma_f32_16x16x32_bf16 v[160:163], a[52:55], v[180:183], v[160:163]
    v_mfma_f32_16x16x32_bf16 v[128:131], a[116:119], v[36:39], v[128:131]
    v_mfma_f32_16x16x32_bf16 v[132:135], a[116:119], v[40:43], v[132:135]
    v_mfma_f32_16x16x32_bf16 v[136:139], a[116:119], v[44:47], v[136:139]
    v_mfma_f32_16x16x32_bf16 v[140:143], a[116:119], v[48:51], v[140:143]
    v_mfma_f32_16x16x32_bf16 v[164:167], a[116:119], v[180:183], v[164:167]
    v_mfma_f32_16x16x32_bf16 v[144:147], v[36:39], a[180:183], v[144:147]
    v_mfma_f32_16x16x32_bf16 v[148:151], v[40:43], a[180:183], v[148:151]
    v_mfma_f32_16x16x32_bf16 v[152:155], v[44:47], a[180:183], v[152:155]
    v_mfma_f32_16x16x32_bf16 v[156:159], v[48:51], a[180:183], v[156:159]
    v_mfma_f32_16x16x32_bf16 v[168:171], v[180:183], a[180:183], v[168:171]
    v_mfma_f32_16x16x32_bf16 v[172:175], v[52:55], v[52:55], v[172:175]
    v_mfma_f32_16x16x32_bf16 v[176:179], v[52:55], v[180:183], v[176:179]
    ds_read_b128 v[36:39], v15 offset:768
    ds_read_b128 v[40:43], v191 offset:17152
    ds_read_b128 v[44:47], v14 offset:33536
    ds_read_b128 v[48:51], v190 offset:49920
    ds_read_b128 v[52:55], v187 offset:768
    s_waitcnt vmcnt(3) lgkmcnt(5)
    v_mfma_f32_16x16x32_bf16 v[112:115], a[56:59], v[16:19], v[112:115]
    v_mfma_f32_16x16x32_bf16 v[116:119], a[56:59], v[20:23], v[116:119]
    v_mfma_f32_16x16x32_bf16 v[120:123], a[56:59], v[24:27], v[120:123]
    v_mfma_f32_16x16x32_bf16 v[124:127], a[56:59], v[28:31], v[124:127]
    v_mfma_f32_16x16x32_bf16 v[160:163], a[56:59], v[180:183], v[160:163]
    v_mfma_f32_16x16x32_bf16 v[128:131], a[120:123], v[16:19], v[128:131]
    v_mfma_f32_16x16x32_bf16 v[132:135], a[120:123], v[20:23], v[132:135]
    v_mfma_f32_16x16x32_bf16 v[136:139], a[120:123], v[24:27], v[136:139]
    v_mfma_f32_16x16x32_bf16 v[140:143], a[120:123], v[28:31], v[140:143]
    v_mfma_f32_16x16x32_bf16 v[164:167], a[120:123], v[180:183], v[164:167]
    v_mfma_f32_16x16x32_bf16 v[144:147], v[16:19], a[184:187], v[144:147]
    v_mfma_f32_16x16x32_bf16 v[148:151], v[20:23], a[184:187], v[148:151]
    v_mfma_f32_16x16x32_bf16 v[152:155], v[24:27], a[184:187], v[152:155]
    v_mfma_f32_16x16x32_bf16 v[156:159], v[28:31], a[184:187], v[156:159]
    v_mfma_f32_16x16x32_bf16 v[168:171], v[180:183], a[184:187], v[168:171]
    v_mfma_f32_16x16x32_bf16 v[172:175], v[32:35], v[32:35], v[172:175]
    v_mfma_f32_16x16x32_bf16 v[176:179], v[32:35], v[180:183], v[176:179]
    s_waitcnt vmcnt(0) lgkmcnt(0)
    v_mfma_f32_16x16x32_bf16 v[112:115], a[60:63], v[36:39], v[112:115]
    v_mfma_f32_16x16x32_bf16 v[116:119], a[60:63], v[40:43], v[116:119]
    v_mfma_f32_16x16x32_bf16 v[120:123], a[60:63], v[44:47], v[120:123]
    v_mfma_f32_16x16x32_bf16 v[124:127], a[60:63], v[48:51], v[124:127]
    v_mfma_f32_16x16x32_bf16 v[160:163], a[60:63], v[180:183], v[160:163]
    v_mfma_f32_16x16x32_bf16 v[128:131], a[124:127], v[36:39], v[128:131]
    v_mfma_f32_16x16x32_bf16 v[132:135], a[124:127], v[40:43], v[132:135]
    v_mfma_f32_16x16x32_bf16 v[136:139], a[124:127], v[44:47], v[136:139]
    v_mfma_f32_16x16x32_bf16 v[140:143], a[124:127], v[48:51], v[140:143]
    v_mfma_f32_16x16x32_bf16 v[164:167], a[124:127], v[180:183], v[164:167]
    v_mfma_f32_16x16x32_bf16 v[144:147], v[36:39], a[188:191], v[144:147]
    v_mfma_f32_16x16x32_bf16 v[148:151], v[40:43], a[188:191], v[148:151]
    v_mfma_f32_16x16x32_bf16 v[152:155], v[44:47], a[188:191], v[152:155]
    v_mfma_f32_16x16x32_bf16 v[156:159], v[48:51], a[188:191], v[156:159]
    v_mfma_f32_16x16x32_bf16 v[168:171], v[180:183], a[188:191], v[168:171]
    v_mfma_f32_16x16x32_bf16 v[172:175], v[52:55], v[52:55], v[172:175]
    v_mfma_f32_16x16x32_bf16 v[176:179], v[52:55], v[180:183], v[176:179]
    s_nop 7
    s_nop 1
    v_lshlrev_b32 v9, 4, v2
    buffer_store_dwordx4 v[160:163], v9, s[8:11], s28 offen offset:0
    buffer_store_dwordx4 v[164:167], v9, s[8:11], s28 offen offset:1024
    buffer_store_dwordx4 v[168:171], v9, s[8:11], s28 offen offset:2048
    v_and_b32 v10, 3, v3
    v_mov_b32 v16, v172
    v_mov_b32 v17, v176
    v_cmp_eq_u32 vcc, 1, v10
    s_nop 1
    v_cndmask_b32 v16, v16, v173, vcc
    v_cndmask_b32 v17, v17, v177, vcc
    v_cmp_eq_u32 vcc, 2, v10
    s_nop 1
    v_cndmask_b32 v16, v16, v174, vcc
    v_cndmask_b32 v17, v17, v178, vcc
    v_cmp_eq_u32 vcc, 3, v10
    s_nop 1
    v_cndmask_b32 v16, v16, v175, vcc
    v_cndmask_b32 v17, v17, v179, vcc
    s_mov_b32 s18, 0x3b000000
    s_mov_b32 s19, 0x3727c5ac
    v_mul_f32 v17, s18, v17
    v_mul_f32 v16, s18, v16
    v_fma_f32 v16, -v17, v17, v16
    v_max_f32 v16, 0, v16
    v_cvt_pk_bf16_f32 v17, v17, v17
    v_lshlrev_b32 v17, 16, v17
    v_cvt_pk_bf16_f32 v16, v16, v16
    v_lshlrev_b32 v16, 16, v16
    v_add_f32 v16, s19, v16
    v_cvt_pk_bf16_f32 v16, v16, v16
    v_lshlrev_b32 v16, 16, v16
    v_sqrt_f32 v16, v16
    s_nop 0
    v_cvt_pk_bf16_f32 v16, v16, v16
    v_lshlrev_b32 v16, 16, v16
    v_rcp_f32 v16, v16
    s_barrier
    v_lshrrev_b32 v10, 2, v3
    v_cmp_eq_u32 vcc, v10, v4
    v_lshl_add_u32 v11, v1, 4, v3
    v_lshlrev_b32 v11, 3, v11
    s_and_saveexec_b64 s[30:31], vcc
    ds_write_b64 v11, v[16:17]
    s_mov_b64 exec, s[30:31]
    s_waitcnt lgkmcnt(0)
    s_barrier
    v_lshlrev_b32 v11, 3, v3
    ds_read_b64 v[20:21], v11 offset:0
    ds_read_b64 v[22:23], v11 offset:128
    ds_read_b64 v[24:25], v11 offset:256
    ds_read_b64 v[26:27], v11 offset:384
    v_lshlrev_b32 v12, 5, v4
    ds_read_b128 v[32:35], v12 offset:0
    ds_read_b128 v[36:39], v12 offset:16
    ds_read_b128 v[40:43], v12 offset:128
    ds_read_b128 v[44:47], v12 offset:144
    ds_read_b128 v[48:51], v12 offset:256
    ds_read_b128 v[52:55], v12 offset:272
    ds_read_b128 v[56:59], v12 offset:384
    ds_read_b128 v[60:63], v12 offset:400
    s_waitcnt lgkmcnt(8)
    s_lshl_b32 s16, s5, 6
    v_add_u32 v10, s16, v3
    s_lshl_b32 s23, s6, 16
    s_add_u32 s23, s23, 16777216
    s_add_u32 s24, s23, 2097152
    s_lshl_b32 s25, s5, 11
    s_add_u32 s25, s25, s23
    s_add_u32 s25, s25, 4194304
    v_lshlrev_b32 v11, 5, v10
    v_lshl_add_u32 v11, v4, 3, v11
    v_fma_f32 v112, -v21, v160, v112
    v_mul_f32 v112, v112, v20
    v_fma_f32 v113, -v21, v161, v113
    v_mul_f32 v113, v113, v20
    v_fma_f32 v114, -v21, v162, v114
    v_mul_f32 v114, v114, v20
    v_fma_f32 v115, -v21, v163, v115
    v_mul_f32 v115, v115, v20
    v_cvt_pk_bf16_f32 v112, v112, v113
    v_cvt_pk_bf16_f32 v113, v114, v115
    buffer_store_dwordx2 v[112:113], v11, s[8:11], s23 offen offset:0
    v_fma_f32 v116, -v23, v160, v116
    v_mul_f32 v116, v116, v22
    v_fma_f32 v117, -v23, v161, v117
    v_mul_f32 v117, v117, v22
    v_fma_f32 v118, -v23, v162, v118
    v_mul_f32 v118, v118, v22
    v_fma_f32 v119, -v23, v163, v119
    v_mul_f32 v119, v119, v22
    v_cvt_pk_bf16_f32 v116, v116, v117
    v_cvt_pk_bf16_f32 v117, v118, v119
    buffer_store_dwordx2 v[116:117], v11, s[8:11], s23 offen offset:512
    v_fma_f32 v120, -v25, v160, v120
    v_mul_f32 v120, v120, v24
    v_fma_f32 v121, -v25, v161, v121
    v_mul_f32 v121, v121, v24
    v_fma_f32 v122, -v25, v162, v122
    v_mul_f32 v122, v122, v24
    v_fma_f32 v123, -v25, v163, v123
    v_mul_f32 v123, v123, v24
    v_cvt_pk_bf16_f32 v120, v120, v121
    v_cvt_pk_bf16_f32 v121, v122, v123
    buffer_store_dwordx2 v[120:121], v11, s[8:11], s23 offen offset:1024
    v_fma_f32 v124, -v27, v160, v124
    v_mul_f32 v124, v124, v26
    v_fma_f32 v125, -v27, v161, v125
    v_mul_f32 v125, v125, v26
    v_fma_f32 v126, -v27, v162, v126
    v_mul_f32 v126, v126, v26
    v_fma_f32 v127, -v27, v163, v127
    v_mul_f32 v127, v127, v26
    v_cvt_pk_bf16_f32 v124, v124, v125
    v_cvt_pk_bf16_f32 v125, v126, v127
    buffer_store_dwordx2 v[124:125], v11, s[8:11], s23 offen offset:1536
    v_fma_f32 v128, -v21, v164, v128
    v_mul_f32 v128, v128, v20
    v_fma_f32 v129, -v21, v165, v129
    v_mul_f32 v129, v129, v20
    v_fma_f32 v130, -v21, v166, v130
    v_mul_f32 v130, v130, v20
    v_fma_f32 v131, -v21, v167, v131
    v_mul_f32 v131, v131, v20
    v_cvt_pk_bf16_f32 v128, v128, v129
    v_cvt_pk_bf16_f32 v129, v130, v131
    buffer_store_dwordx2 v[128:129], v11, s[8:11], s24 offen offset:0
    v_fma_f32 v132, -v23, v164, v132
    v_mul_f32 v132, v132, v22
    v_fma_f32 v133, -v23, v165, v133
    v_mul_f32 v133, v133, v22
    v_fma_f32 v134, -v23, v166, v134
    v_mul_f32 v134, v134, v22
    v_fma_f32 v135, -v23, v167, v135
    v_mul_f32 v135, v135, v22
    v_cvt_pk_bf16_f32 v132, v132, v133
    v_cvt_pk_bf16_f32 v133, v134, v135
    buffer_store_dwordx2 v[132:133], v11, s[8:11], s24 offen offset:512
    v_fma_f32 v136, -v25, v164, v136
    v_mul_f32 v136, v136, v24
    v_fma_f32 v137, -v25, v165, v137
    v_mul_f32 v137, v137, v24
    v_fma_f32 v138, -v25, v166, v138
    v_mul_f32 v138, v138, v24
    v_fma_f32 v139, -v25, v167, v139
    v_mul_f32 v139, v139, v24
    v_cvt_pk_bf16_f32 v136, v136, v137
    v_cvt_pk_bf16_f32 v137, v138, v139
    buffer_store_dwordx2 v[136:137], v11, s[8:11], s24 offen offset:1024
    v_fma_f32 v140, -v27, v164, v140
    v_mul_f32 v140, v140, v26
    v_fma_f32 v141, -v27, v165, v141
    v_mul_f32 v141, v141, v26
    v_fma_f32 v142, -v27, v166, v142
    v_mul_f32 v142, v142, v26
    v_fma_f32 v143, -v27, v167, v143
    v_mul_f32 v143, v143, v26
    v_cvt_pk_bf16_f32 v140, v140, v141
    v_cvt_pk_bf16_f32 v141, v142, v143
    buffer_store_dwordx2 v[140:141], v11, s[8:11], s24 offen offset:1536
    v_lshrrev_b32 v11, 1, v4
    v_lshlrev_b32 v11, 8, v11
    v_lshl_add_u32 v11, v3, 4, v11
    v_and_b32 v12, 1, v4
    v_lshl_add_u32 v11, v12, 3, v11
    s_waitcnt lgkmcnt(0)
    v_fma_f32 v144, -v33, v168, v144
    v_mul_f32 v144, v144, v32
    v_fma_f32 v145, -v35, v168, v145
    v_mul_f32 v145, v145, v34
    v_fma_f32 v146, -v37, v168, v146
    v_mul_f32 v146, v146, v36
    v_fma_f32 v147, -v39, v168, v147
    v_mul_f32 v147, v147, v38
    v_cvt_pk_bf16_f32 v144, v144, v145
    v_cvt_pk_bf16_f32 v145, v146, v147
    buffer_store_dwordx2 v[144:145], v11, s[8:11], s25 offen offset:0
    v_fma_f32 v148, -v41, v168, v148
    v_mul_f32 v148, v148, v40
    v_fma_f32 v149, -v43, v168, v149
    v_mul_f32 v149, v149, v42
    v_fma_f32 v150, -v45, v168, v150
    v_mul_f32 v150, v150, v44
    v_fma_f32 v151, -v47, v168, v151
    v_mul_f32 v151, v151, v46
    v_cvt_pk_bf16_f32 v148, v148, v149
    v_cvt_pk_bf16_f32 v149, v150, v151
    buffer_store_dwordx2 v[148:149], v11, s[8:11], s25 offen offset:512
    v_fma_f32 v152, -v49, v168, v152
    v_mul_f32 v152, v152, v48
    v_fma_f32 v153, -v51, v168, v153
    v_mul_f32 v153, v153, v50
    v_fma_f32 v154, -v53, v168, v154
    v_mul_f32 v154, v154, v52
    v_fma_f32 v155, -v55, v168, v155
    v_mul_f32 v155, v155, v54
    v_cvt_pk_bf16_f32 v152, v152, v153
    v_cvt_pk_bf16_f32 v153, v154, v155
    buffer_store_dwordx2 v[152:153], v11, s[8:11], s25 offen offset:1024
    v_fma_f32 v156, -v57, v168, v156
    v_mul_f32 v156, v156, v56
    v_fma_f32 v157, -v59, v168, v157
    v_mul_f32 v157, v157, v58
    v_fma_f32 v158, -v61, v168, v158
    v_mul_f32 v158, v158, v60
    v_fma_f32 v159, -v63, v168, v159
    v_mul_f32 v159, v159, v62
    v_cvt_pk_bf16_f32 v156, v156, v157
    v_cvt_pk_bf16_f32 v157, v158, v159
    buffer_store_dwordx2 v[156:157], v11, s[8:11], s25 offen offset:1536
L_end_qkv1_kernel:
    s_endpgm
.section .rodata,"a"
.p2align 6
.amdhsa_kernel qkv1_kernel
  .amdhsa_next_free_vgpr 384
  .amdhsa_next_free_sgpr 96
  .amdhsa_accum_offset 192
  .amdhsa_group_segment_fixed_size 0
  .amdhsa_kernarg_size 120
  .amdhsa_user_sgpr_count 2
  .amdhsa_user_sgpr_kernarg_segment_ptr 1
  .amdhsa_system_sgpr_workgroup_id_x 1
.end_amdhsa_kernel
.text

.globl qkv2_kernel
.p2align 8
.type qkv2_kernel,@function
qkv2_kernel:
    s_cmp_ge_u32 s2, 256
    s_cbranch_scc1 L_end_qkv2_kernel
    s_load_dwordx2 s[8:9], s[0:1], 112
    s_mov_b32 s10, 25165824
    s_mov_b32 s11, 0x00020000
    s_mov_b32 s20, 0x05040100
    s_mov_b32 s21, 0x07060302
    v_lshrrev_b32 v1, 6, v0
    v_and_b32 v2, 63, v0
    v_and_b32 v3, 15, v2
    v_lshrrev_b32 v4, 4, v2
    s_nop 0
    v_readfirstlane_b32 s4, v1
    s_bfe_u32 s5, s2, 0x20001
    s_lshl_b32 s5, s5, 3
    s_lshr_b32 s6, s2, 5
    s_add_u32 s5, s5, s6
    s_and_b32 s6, s2, 1
    s_lshl_b32 s6, s6, 2
    s_bfe_u32 s7, s2, 0x20003
    s_add_u32 s6, s6, s7
    s_lshl_b32 s6, s6, 2
    s_add_u32 s6, s6, s4
    s_lshl_b32 s7, s6, 14
    s_add_u32 s7, s7, 13631488
    s_lshl_b32 s16, s5, 7
    s_add_u32 s16, s16, 6291456
    s_waitcnt lgkmcnt(0)
    v_and_b32 v5, 7, v0
    v_lshrrev_b32 v6, 3, v0
    v_lshlrev_b32 v7, 15, v6
    v_lshl_add_u32 v7, v5, 4, v7
    v_add_u32 v8, 0x100000, v7
    buffer_load_dwordx4 v[16:19], v7, s[8:11], s16 offen
    buffer_load_dwordx4 v[48:51], v8, s[8:11], s16 offen
    v_add_u32 v7, 4096, v7
    v_add_u32 v8, 4096, v8
    buffer_load_dwordx4 v[20:23], v7, s[8:11], s16 offen
    buffer_load_dwordx4 v[52:55], v8, s[8:11], s16 offen
    v_add_u32 v7, 4096, v7
    v_add_u32 v8, 4096, v8
    buffer_load_dwordx4 v[24:27], v7, s[8:11], s16 offen
    buffer_load_dwordx4 v[56:59], v8, s[8:11], s16 offen
    v_add_u32 v7, 4096, v7
    v_add_u32 v8, 4096, v8
    buffer_load_dwordx4 v[28:31], v7, s[8:11], s16 offen
    buffer_load_dwordx4 v[60:63], v8, s[8:11], s16 offen
    v_add_u32 v7, 4096, v7
    v_add_u32 v8, 4096, v8
    buffer_load_dwordx4 v[32:35], v7, s[8:11], s16 offen
    buffer_load_dwordx4 v[64:67], v8, s[8:11], s16 offen
    v_add_u32 v7, 4096, v7
    v_add_u32 v8, 4096, v8
    buffer_load_dwordx4 v[36:39], v7, s[8:11], s16 offen
    buffer_load_dwordx4 v[68:71], v8, s[8:11], s16 offen
    v_add_u32 v7, 4096, v7
    v_add_u32 v8, 4096, v8
    buffer_load_dwordx4 v[40:43], v7, s[8:11], s16 offen
    buffer_load_dwordx4 v[72:75], v8, s[8:11], s16 offen
    v_add_u32 v7, 4096, v7
    v_add_u32 v8, 4096, v8
    buffer_load_dwordx4 v[44:47], v7, s[8:11], s16 offen
    buffer_load_dwordx4 v[76:79], v8, s[8:11], s16 offen
    v_add_u32 v7, 4096, v7
    v_add_u32 v8, 4096, v8
    v_lshlrev_b32 v9, 4, v2
    s_add_u32 s26, s7, 0x80000
    s_add_u32 s27, s7, 0x100000
    s_mul_i32 s28, s6, 3072
    s_add_u32 s28, s28, 8912896
    buffer_load_dwordx4 v[160:163], v9, s[8:11], s28 offen offset:0
    buffer_load_dwordx4 v[164:167], v9, s[8:11], s28 offen offset:1024
    buffer_load_dwordx4 v[168:171], v9, s[8:11], s28 offen offset:2048
    buffer_load_dwordx4 a[0:3], v9, s[8:11], s7 offen offset:0
    buffer_load_dwordx4 a[64:67], v9, s[8:11], s26 offen offset:0
    buffer_load_dwordx4 a[128:131], v9, s[8:11], s27 offen offset:0
    buffer_load_dwordx4 a[4:7], v9, s[8:11], s7 offen offset:1024
    buffer_load_dwordx4 a[68:71], v9, s[8:11], s26 offen offset:1024
    buffer_load_dwordx4 a[132:135], v9, s[8:11], s27 offen offset:1024
    buffer_load_dwordx4 a[8:11], v9, s[8:11], s7 offen offset:2048
    buffer_load_dwordx4 a[72:75], v9, s[8:11], s26 offen offset:2048
    buffer_load_dwordx4 a[136:139], v9, s[8:11], s27 offen offset:2048
    v_lshrrev_b32 v10, 3, v3
    v_xor_b32 v10, v10, v3
    v_xor_b32 v10, v10, v4
    v_lshlrev_b32 v8, 1, v1
    v_xor_b32 v8, v8, v10
    v_lshlrev_b32 v7, 10, v3
    v_lshl_add_u32 v7, v1, 14, v7
    v_xor_b32 v11, 0, v10
    v_lshlrev_b32 v11, 4, v11
    v_lshl_add_u32 v12, v3, 10, v11
    v_xor_b32 v11, 2, v10
    v_lshlrev_b32 v11, 4, v11
    v_lshl_add_u32 v188, v3, 10, v11
    v_xor_b32 v11, 0, v8
    v_lshl_add_u32 v184, v11, 4, v7
    v_xor_b32 v11, 4, v10
    v_lshlrev_b32 v11, 4, v11
    v_lshl_add_u32 v13, v3, 10, v11
    v_xor_b32 v11, 6, v10
    v_lshlrev_b32 v11, 4, v11
    v_lshl_add_u32 v189, v3, 10, v11
    v_xor_b32 v11, 4, v8
    v_lshl_add_u32 v185, v11, 4, v7
    v_xor_b32 v11, 8, v10
    v_lshlrev_b32 v11, 4, v11
    v_lshl_add_u32 v14, v3, 10, v11
    v_xor_b32 v11, 10, v10
    v_lshlrev_b32 v11, 4, v11
    v_lshl_add_u32 v190, v3, 10, v11
    v_xor_b32 v11, 8, v8
    v_lshl_add_u32 v186, v11, 4, v7
    v_xor_b32 v11, 12, v10
    v_lshlrev_b32 v11, 4, v11
    v_lshl_add_u32 v15, v3, 10, v11
    v_xor_b32 v11, 14, v10
    v_lshlrev_b32 v11, 4, v11
    v_lshl_add_u32 v191, v3, 10, v11
    v_xor_b32 v11, 12, v8
    v_lshl_add_u32 v187, v11, 4, v7
    v_and_b32 v10, 1, v5
    v_lshlrev_b32 v10, 3, v10
    v_xor_b32 v10, v10, v5
    v_xor_b32 v10, v10, v6
    v_lshlrev_b32 v10, 4, v10
    v_lshl_add_u32 v7, v5, 13, v10
    s_mul_i32 s28, s6, 3072
    s_add_u32 s28, s28, 8912896
    v_mov_b32 v112, 0
    v_mov_b32 v113, 0
    v_mov_b32 v114, 0
    v_mov_b32 v115, 0
    v_mov_b32 v116, 0
    v_mov_b32 v117, 0
    v_mov_b32 v118, 0
    v_mov_b32 v119, 0
    v_mov_b32 v120, 0
    v_mov_b32 v121, 0
    v_mov_b32 v122, 0
    v_mov_b32 v123, 0
    v_mov_b32 v124, 0
    v_mov_b32 v125, 0
    v_mov_b32 v126, 0
    v_mov_b32 v127, 0
    v_mov_b32 v128, 0
    v_mov_b32 v129, 0
    v_mov_b32 v130, 0
    v_mov_b32 v131, 0
    v_mov_b32 v132, 0
    v_mov_b32 v133, 0
    v_mov_b32 v134, 0
    v_mov_b32 v135, 0
    v_mov_b32 v136, 0
    v_mov_b32 v137, 0
    v_mov_b32 v138, 0
    v_mov_b32 v139, 0
    v_mov_b32 v140, 0
    v_mov_b32 v141, 0
    v_mov_b32 v142, 0
    v_mov_b32 v143, 0
    v_mov_b32 v144, 0
    v_mov_b32 v145, 0
    v_mov_b32 v146, 0
    v_mov_b32 v147, 0
    v_mov_b32 v148, 0
    v_mov_b32 v149, 0
    v_mov_b32 v150, 0
    v_mov_b32 v151, 0
    v_mov_b32 v152, 0
    v_mov_b32 v153, 0
    v_mov_b32 v154, 0
    v_mov_b32 v155, 0
    v_mov_b32 v156, 0
    v_mov_b32 v157, 0
    v_mov_b32 v158, 0
    v_mov_b32 v159, 0
    v_mov_b32 v172, 0
    v_mov_b32 v173, 0
    v_mov_b32 v174, 0
    v_mov_b32 v175, 0
    v_mov_b32 v176, 0
    v_mov_b32 v177, 0
    v_mov_b32 v178, 0
    v_mov_b32 v179, 0
    v_mov_b32 v180, 0x3f803f80
    v_mov_b32 v181, 0x3f803f80
    v_mov_b32 v182, 0x3f803f80
    v_mov_b32 v183, 0x3f803f80
    s_waitcnt vmcnt(12)
    v_perm_b32 v80, v20, v16, s20
    v_perm_b32 v81, v28, v24, s20
    v_perm_b32 v82, v36, v32, s20
    v_perm_b32 v83, v44, v40, s20
    v_perm_b32 v84, v20, v16, s21
    v_perm_b32 v85, v28, v24, s21
    v_perm_b32 v86, v36, v32, s21
    v_perm_b32 v87, v44, v40, s21
    v_perm_b32 v88, v21, v17, s20
    v_perm_b32 v89, v29, v25, s20
    v_perm_b32 v90, v37, v33, s20
    v_perm_b32 v91, v45, v41, s20
    v_perm_b32 v92, v21, v17, s21
    v_perm_b32 v93, v29, v25, s21
    v_perm_b32 v94, v37, v33, s21
    v_perm_b32 v95, v45, v41, s21
    v_perm_b32 v96, v22, v18, s20
    v_perm_b32 v97, v30, v26, s20
    v_perm_b32 v98, v38, v34, s20
    v_perm_b32 v99, v46, v42, s20
    v_perm_b32 v100, v22, v18, s21
    v_perm_b32 v101, v30, v26, s21
    v_perm_b32 v102, v38, v34, s21
    v_perm_b32 v103, v46, v42, s21
    v_perm_b32 v104, v23, v19, s20
    v_perm_b32 v105, v31, v27, s20
    v_perm_b32 v106, v39, v35, s20
    v_perm_b32 v107, v47, v43, s20
    v_perm_b32 v108, v23, v19, s21
    v_perm_b32 v109, v31, v27, s21
    v_perm_b32 v110, v39, v35, s21
    v_perm_b32 v111, v47, v43, s21
    v_xor_b32 v10, 0, v7
    ds_write_b128 v10, v[80:83] offset:0
    buffer_load_dwordx4 a[12:15], v9, s[8:11], s7 offen offset:3072
    v_xor_b32 v11, 16, v7
    ds_write_b128 v11, v[84:87] offset:1024
    buffer_load_dwordx4 a[76:79], v9, s[8:11], s26 offen offset:3072
    v_xor_b32 v10, 32, v7
    ds_write_b128 v10, v[88:91] offset:2048
    buffer_load_dwordx4 a[140:143], v9, s[8:11], s27 offen offset:3072
    v_add_u32 v9, 4096, v9
    v_xor_b32 v11, 48, v7
    ds_write_b128 v11, v[92:95] offset:3072
    buffer_load_dwordx4 a[16:19], v9, s[8:11], s7 offen offset:0
    v_xor_b32 v10, 64, v7
    ds_write_b128 v10, v[96:99] offset:4096
    buffer_load_dwordx4 a[80:83], v9, s[8:11], s26 offen offset:0
    v_xor_b32 v11, 80, v7
    ds_write_b128 v11, v[100:103] offset:5120
    buffer_load_dwordx4 a[144:147], v9, s[8:11], s27 offen offset:0
    v_xor_b32 v10, 96, v7
    ds_write_b128 v10, v[104:107] offset:6144
    v_xor_b32 v11, 112, v7
    ds_write_b128 v11, v[108:111] offset:7168
    v_perm_b32 v80, v52, v48, s20
    v_perm_b32 v81, v60, v56, s20
    v_perm_b32 v82, v68, v64, s20
    v_perm_b32 v83, v76, v72, s20
    v_perm_b32 v84, v52, v48, s21
    v_perm_b32 v85, v60, v56, s21
    v_perm_b32 v86, v68, v64, s21
    v_perm_b32 v87, v76, v72, s21
    v_perm_b32 v88, v53, v49, s20
    v_perm_b32 v89, v61, v57, s20
    v_perm_b32 v90, v69, v65, s20
    v_perm_b32 v91, v77, v73, s20
    v_perm_b32 v92, v53, v49, s21
    v_perm_b32 v93, v61, v57, s21
    v_perm_b32 v94, v69, v65, s21
    v_perm_b32 v95, v77, v73, s21
    v_perm_b32 v96, v54, v50, s20
    v_perm_b32 v97, v62, v58, s20
    v_perm_b32 v98, v70, v66, s20
    v_perm_b32 v99, v78, v74, s20
    v_perm_b32 v100, v54, v50, s21
    v_perm_b32 v101, v62, v58, s21
    v_perm_b32 v102, v70, v66, s21
    v_perm_b32 v103, v78, v74, s21
    v_perm_b32 v104, v55, v51, s20
    v_perm_b32 v105, v63, v59, s20
    v_perm_b32 v106, v71, v67, s20
    v_perm_b32 v107, v79, v75, s20
    v_perm_b32 v108, v55, v51, s21
    v_perm_b32 v109, v63, v59, s21
    v_perm_b32 v110, v71, v67, s21
    v_perm_b32 v111, v79, v75, s21
    v_xor_b32 v10, 0, v7
    ds_write_b128 v10, v[80:83] offset:512
    buffer_load_dwordx4 a[20:23], v9, s[8:11], s7 offen offset:1024
    v_xor_b32 v11, 16, v7
    ds_write_b128 v11, v[84:87] offset:1536
    buffer_load_dwordx4 a[84:87], v9, s[8:11], s26 offen offset:1024
    v_xor_b32 v10, 32, v7
    ds_write_b128 v10, v[88:91] offset:2560
    buffer_load_dwordx4 a[148:151], v9, s[8:11], s27 offen offset:1024
    v_xor_b32 v11, 48, v7
    ds_write_b128 v11, v[92:95] offset:3584
    buffer_load_dwordx4 a[24:27], v9, s[8:11], s7 offen offset:2048
    v_xor_b32 v10, 64, v7
    ds_write_b128 v10, v[96:99] offset:4608
    buffer_load_dwordx4 a[88:91], v9, s[8:11], s26 offen offset:2048
    v_xor_b32 v11, 80, v7
    ds_write_b128 v11, v[100:103] offset:5632
    buffer_load_dwordx4 a[152:155], v9, s[8:11], s27 offen offset:2048
    v_xor_b32 v10, 96, v7
    ds_write_b128 v10, v[104:107] offset:6656
    v_xor_b32 v11, 112, v7
    ds_write_b128 v11, v[108:111] offset:7680
    s_waitcnt lgkmcnt(0)
    s_barrier
    ds_read_b128 v[16:19], v12 offset:0
    ds_read_b128 v[20:23], v188 offset:16384
    ds_read_b128 v[24:27], v13 offset:32768
    ds_read_b128 v[28:31], v189 offset:49152
    ds_read_b128 v[32:35], v184 offset:0
    ds_read_b128 v[36:39], v13 offset:0
    ds_read_b128 v[40:43], v189 offset:16384
    ds_read_b128 v[44:47], v12 offset:32768
    ds_read_b128 v[48:51], v188 offset:49152
    ds_read_b128 v[52:55], v185 offset:0
    buffer_load_dwordx4 a[28:31], v9, s[8:11], s7 offen offset:3072
    buffer_load_dwordx4 a[92:95], v9, s[8:11], s26 offen offset:3072
    buffer_load_dwordx4 a[156:159], v9, s[8:11], s27 offen offset:3072
    v_add_u32 v9, 4096, v9
    s_waitcnt vmcnt(21) lgkmcnt(5)
    v_mfma_f32_16x16x32_bf16 v[112:115], a[0:3], v[16:19], v[112:115]
    v_mfma_f32_16x16x32_bf16 v[116:119], a[0:3], v[20:23], v[116:119]
    v_mfma_f32_16x16x32_bf16 v[120:123], a[0:3], v[24:27], v[120:123]
    v_mfma_f32_16x16x32_bf16 v[124:127], a[0:3], v[28:31], v[124:127]
    v_mfma_f32_16x16x32_bf16 v[128:131], a[64:67], v[16:19], v[128:131]
    v_mfma_f32_16x16x32_bf16 v[132:135], a[64:67], v[20:23], v[132:135]
    v_mfma_f32_16x16x32_bf16 v[136:139], a[64:67], v[24:27], v[136:139]
    v_mfma_f32_16x16x32_bf16 v[140:143], a[64:67], v[28:31], v[140:143]
    v_mfma_f32_16x16x32_bf16 v[144:147], v[16:19], a[128:131], v[144:147]
    v_mfma_f32_16x16x32_bf16 v[148:151], v[20:23], a[128:131], v[148:151]
    v_mfma_f32_16x16x32_bf16 v[152:155], v[24:27], a[128:131], v[152:155]
    v_mfma_f32_16x16x32_bf16 v[156:159], v[28:31], a[128:131], v[156:159]
    v_mfma_f32_16x16x32_bf16 v[172:175], v[32:35], v[32:35], v[172:175]
    v_mfma_f32_16x16x32_bf16 v[176:179], v[32:35], v[180:183], v[176:179]
    ds_read_b128 v[16:19], v14 offset:0
    ds_read_b128 v[20:23], v190 offset:16384
    ds_read_b128 v[24:27], v15 offset:32768
    ds_read_b128 v[28:31], v191 offset:49152
    ds_read_b128 v[32:35], v186 offset:0
    buffer_load_dwordx4 a[32:35], v9, s[8:11], s7 offen offset:0
    buffer_load_dwordx4 a[96:99], v9, s[8:11], s26 offen offset:0
    buffer_load_dwordx4 a[160:163], v9, s[8:11], s27 offen offset:0
    s_waitcnt vmcnt(21) lgkmcnt(5)
    v_mfma_f32_16x16x32_bf16 v[112:115], a[4:7], v[36:39], v[112:115]
    v_mfma_f32_16x16x32_bf16 v[116:119], a[4:7], v[40:43], v[116:119]
    v_mfma_f32_16x16x32_bf16 v[120:123], a[4:7], v[44:47], v[120:123]
    v_mfma_f32_16x16x32_bf16 v[124:127], a[4:7], v[48:51], v[124:127]
    v_mfma_f32_16x16x32_bf16 v[128:131], a[68:71], v[36:39], v[128:131]
    v_mfma_f32_16x16x32_bf16 v[132:135], a[68:71], v[40:43], v[132:135]
    v_mfma_f32_16x16x32_bf16 v[136:139], a[68:71], v[44:47], v[136:139]
    v_mfma_f32_16x16x32_bf16 v[140:143], a[68:71], v[48:51], v[140:143]
    v_mfma_f32_16x16x32_bf16 v[144:147], v[36:39], a[132:135], v[144:147]
    v_mfma_f32_16x16x32_bf16 v[148:151], v[40:43], a[132:135], v[148:151]
    v_mfma_f32_16x16x32_bf16 v[152:155], v[44:47], a[132:135], v[152:155]
    v_mfma_f32_16x16x32_bf16 v[156:159], v[48:51], a[132:135], v[156:159]
    v_mfma_f32_16x16x32_bf16 v[172:175], v[52:55], v[52:55], v[172:175]
    v_mfma_f32_16x16x32_bf16 v[176:179], v[52:55], v[180:183], v[176:179]
    ds_read_b128 v[36:39], v15 offset:0
    ds_read_b128 v[40:43], v191 offset:16384
    ds_read_b128 v[44:47], v14 offset:32768
    ds_read_b128 v[48:51], v190 offset:49152
    ds_read_b128 v[52:55], v187 offset:0
    buffer_load_dwordx4 a[36:39], v9, s[8:11], s7 offen offset:1024
    buffer_load_dwordx4 a[100:103], v9, s[8:11], s26 offen offset:1024
    buffer_load_dwordx4 a[164:167], v9, s[8:11], s27 offen offset:1024
    s_waitcnt vmcnt(21) lgkmcnt(5)
    v_mfma_f32_16x16x32_bf16 v[112:115], a[8:11], v[16:19], v[112:115]
    v_mfma_f32_16x16x32_bf16 v[116:119], a[8:11], v[20:23], v[116:119]
    v_mfma_f32_16x16x32_bf16 v[120:123], a[8:11], v[24:27], v[120:123]
    v_mfma_f32_16x16x32_bf16 v[124:127], a[8:11], v[28:31], v[124:127]
    v_mfma_f32_16x16x32_bf16 v[128:131], a[72:75], v[16:19], v[128:131]
    v_mfma_f32_16x16x32_bf16 v[132:135], a[72:75], v[20:23], v[132:135]
    v_mfma_f32_16x16x32_bf16 v[136:139], a[72:75], v[24:27], v[136:139]
    v_mfma_f32_16x16x32_bf16 v[140:143], a[72:75], v[28:31], v[140:143]
    v_mfma_f32_16x16x32_bf16 v[144:147], v[16:19], a[136:139], v[144:147]
    v_mfma_f32_16x16x32_bf16 v[148:151], v[20:23], a[136:139], v[148:151]
    v_mfma_f32_16x16x32_bf16 v[152:155], v[24:27], a[136:139], v[152:155]
    v_mfma_f32_16x16x32_bf16 v[156:159], v[28:31], a[136:139], v[156:159]
    v_mfma_f32_16x16x32_bf16 v[172:175], v[32:35], v[32:35], v[172:175]
    v_mfma_f32_16x16x32_bf16 v[176:179], v[32:35], v[180:183], v[176:179]
    ds_read_b128 v[16:19], v12 offset:256
    ds_read_b128 v[20:23], v188 offset:16640
    ds_read_b128 v[24:27], v13 offset:33024
    ds_read_b128 v[28:31], v189 offset:49408
    ds_read_b128 v[32:35], v184 offset:256
    buffer_load_dwordx4 a[40:43], v9, s[8:11], s7 offen offset:2048
    buffer_load_dwordx4 a[104:107], v9, s[8:11], s26 offen offset:2048
    buffer_load_dwordx4 a[168:171], v9, s[8:11], s27 offen offset:2048
    s_waitcnt vmcnt(21) lgkmcnt(5)
    v_mfma_f32_16x16x32_bf16 v[112:115], a[12:15], v[36:39], v[112:115]
    v_mfma_f32_16x16x32_bf16 v[116:119], a[12:15], v[40:43], v[116:119]
    v_mfma_f32_16x16x32_bf16 v[120:123], a[12:15], v[44:47], v[120:123]
    v_mfma_f32_16x16x32_bf16 v[124:127], a[12:15], v[48:51], v[124:127]
    v_mfma_f32_16x16x32_bf16 v[128:131], a[76:79], v[36:39], v[128:131]
    v_mfma_f32_16x16x32_bf16 v[132:135], a[76:79], v[40:43], v[132:135]
    v_mfma_f32_16x16x32_bf16 v[136:139], a[76:79], v[44:47], v[136:139]
    v_mfma_f32_16x16x32_bf16 v[140:143], a[76:79], v[48:51], v[140:143]
    v_mfma_f32_16x16x32_bf16 v[144:147], v[36:39], a[140:143], v[144:147]
    v_mfma_f32_16x16x32_bf16 v[148:151], v[40:43], a[140:143], v[148:151]
    v_mfma_f32_16x16x32_bf16 v[152:155], v[44:47], a[140:143], v[152:155]
    v_mfma_f32_16x16x32_bf16 v[156:159], v[48:51], a[140:143], v[156:159]
    v_mfma_f32_16x16x32_bf16 v[172:175], v[52:55], v[52:55], v[172:175]
    v_mfma_f32_16x16x32_bf16 v[176:179], v[52:55], v[180:183], v[176:179]
    ds_read_b128 v[36:39], v13 offset:256
    ds_read_b128 v[40:43], v189 offset:16640
    ds_read_b128 v[44:47], v12 offset:33024
    ds_read_b128 v[48:51], v188 offset:49408
    ds_read_b128 v[52:55], v185 offset:256
    buffer_load_dwordx4 a[44:47], v9, s[8:11], s7 offen offset:3072
    buffer_load_dwordx4 a[108:111], v9, s[8:11], s26 offen offset:3072
    buffer_load_dwordx4 a[172:175], v9, s[8:11], s27 offen offset:3072
    v_add_u32 v9, 4096, v9
    s_waitcnt vmcnt(21) lgkmcnt(5)
    v_mfma_f32_16x16x32_bf16 v[112:115], a[16:19], v[16:19], v[112:115]
    v_mfma_f32_16x16x32_bf16 v[116:119], a[16:19], v[20:23], v[116:119]
    v_mfma_f32_16x16x32_bf16 v[120:123], a[16:19], v[24:27], v[120:123]
    v_mfma_f32_16x16x32_bf16 v[124:127], a[16:19], v[28:31], v[124:127]
    v_mfma_f32_16x16x32_bf16 v[128:131], a[80:83], v[16:19], v[128:131]
    v_mfma_f32_16x16x32_bf16 v[132:135], a[80:83], v[20:23], v[132:135]
    v_mfma_f32_16x16x32_bf16 v[136:139], a[80:83], v[24:27], v[136:139]
    v_mfma_f32_16x16x32_bf16 v[140:143], a[80:83], v[28:31], v[140:143]
    v_mfma_f32_16x16x32_bf16 v[144:147], v[16:19], a[144:147], v[144:147]
    v_mfma_f32_16x16x32_bf16 v[148:151], v[20:23], a[144:147], v[148:151]
    v_mfma_f32_16x16x32_bf16 v[152:155], v[24:27], a[144:147], v[152:155]
    v_mfma_f32_16x16x32_bf16 v[156:159], v[28:31], a[144:147], v[156:159]
    v_mfma_f32_16x16x32_bf16 v[172:175], v[32:35], v[32:35], v[172:175]
    v_mfma_f32_16x16x32_bf16 v[176:179], v[32:35], v[180:183], v[176:179]
    ds_read_b128 v[16:19], v14 offset:256
    ds_read_b128 v[20:23], v190 offset:16640
    ds_read_b128 v[24:27], v15 offset:33024
    ds_read_b128 v[28:31], v191 offset:49408
    ds_read_b128 v[32:35], v186 offset:256
    buffer_load_dwordx4 a[48:51], v9, s[8:11], s7 offen offset:0
    buffer_load_dwordx4 a[112:115], v9, s[8:11], s26 offen offset:0
    buffer_load_dwordx4 a[176:179], v9, s[8:11], s27 offen offset:0
    s_waitcnt vmcnt(21) lgkmcnt(5)
    v_mfma_f32_16x16x32_bf16 v[112:115], a[20:23], v[36:39], v[112:115]
    v_mfma_f32_16x16x32_bf16 v[116:119], a[20:23], v[40:43], v[116:119]
    v_mfma_f32_16x16x32_bf16 v[120:123], a[20:23], v[44:47], v[120:123]
    v_mfma_f32_16x16x32_bf16 v[124:127], a[20:23], v[48:51], v[124:127]
    v_mfma_f32_16x16x32_bf16 v[128:131], a[84:87], v[36:39], v[128:131]
    v_mfma_f32_16x16x32_bf16 v[132:135], a[84:87], v[40:43], v[132:135]
    v_mfma_f32_16x16x32_bf16 v[136:139], a[84:87], v[44:47], v[136:139]
    v_mfma_f32_16x16x32_bf16 v[140:143], a[84:87], v[48:51], v[140:143]
    v_mfma_f32_16x16x32_bf16 v[144:147], v[36:39], a[148:151], v[144:147]
    v_mfma_f32_16x16x32_bf16 v[148:151], v[40:43], a[148:151], v[148:151]
    v_mfma_f32_16x16x32_bf16 v[152:155], v[44:47], a[148:151], v[152:155]
    v_mfma_f32_16x16x32_bf16 v[156:159], v[48:51], a[148:151], v[156:159]
    v_mfma_f32_16x16x32_bf16 v[172:175], v[52:55], v[52:55], v[172:175]
    v_mfma_f32_16x16x32_bf16 v[176:179], v[52:55], v[180:183], v[176:179]
    ds_read_b128 v[36:39], v15 offset:256
    ds_read_b128 v[40:43], v191 offset:16640
    ds_read_b128 v[44:47], v14 offset:33024
    ds_read_b128 v[48:51], v190 offset:49408
    ds_read_b128 v[52:55], v187 offset:256
    buffer_load_dwordx4 a[52:55], v9, s[8:11], s7 offen offset:1024
    buffer_load_dwordx4 a[116:119], v9, s[8:11], s26 offen offset:1024
    buffer_load_dwordx4 a[180:183], v9, s[8:11], s27 offen offset:1024
    s_waitcnt vmcnt(21) lgkmcnt(5)
    v_mfma_f32_16x16x32_bf16 v[112:115], a[24:27], v[16:19], v[112:115]
    v_mfma_f32_16x16x32_bf16 v[116:119], a[24:27], v[20:23], v[116:119]
    v_mfma_f32_16x16x32_bf16 v[120:123], a[24:27], v[24:27], v[120:123]
    v_mfma_f32_16x16x32_bf16 v[124:127], a[24:27], v[28:31], v[124:127]
    v_mfma_f32_16x16x32_bf16 v[128:131], a[88:91], v[16:19], v[128:131]
    v_mfma_f32_16x16x32_bf16 v[132:135], a[88:91], v[20:23], v[132:135]
    v_mfma_f32_16x16x32_bf16 v[136:139], a[88:91], v[24:27], v[136:139]
    v_mfma_f32_16x16x32_bf16 v[140:143], a[88:91], v[28:31], v[140:143]
    v_mfma_f32_16x16x32_bf16 v[144:147], v[16:19], a[152:155], v[144:147]
    v_mfma_f32_16x16x32_bf16 v[148:151], v[20:23], a[152:155], v[148:151]
    v_mfma_f32_16x16x32_bf16 v[152:155], v[24:27], a[152:155], v[152:155]
    v_mfma_f32_16x16x32_bf16 v[156:159], v[28:31], a[152:155], v[156:159]
    v_mfma_f32_16x16x32_bf16 v[172:175], v[32:35], v[32:35], v[172:175]
    v_mfma_f32_16x16x32_bf16 v[176:179], v[32:35], v[180:183], v[176:179]
    ds_read_b128 v[16:19], v12 offset:512
    ds_read_b128 v[20:23], v188 offset:16896
    ds_read_b128 v[24:27], v13 offset:33280
    ds_read_b128 v[28:31], v189 offset:49664
    ds_read_b128 v[32:35], v184 offset:512
    buffer_load_dwordx4 a[56:59], v9, s[8:11], s7 offen offset:2048
    buffer_load_dwordx4 a[120:123], v9, s[8:11], s26 offen offset:2048
    buffer_load_dwordx4 a[184:187], v9, s[8:11], s27 offen offset:2048
    s_waitcnt vmcnt(21) lgkmcnt(5)
    v_mfma_f32_16x16x32_bf16 v[112:115], a[28:31], v[36:39], v[112:115]
    v_mfma_f32_16x16x32_bf16 v[116:119], a[28:31], v[40:43], v[116:119]
    v_mfma_f32_16x16x32_bf16 v[120:123], a[28:31], v[44:47], v[120:123]
    v_mfma_f32_16x16x32_bf16 v[124:127], a[28:31], v[48:51], v[124:127]
    v_mfma_f32_16x16x32_bf16 v[128:131], a[92:95], v[36:39], v[128:131]
    v_mfma_f32_16x16x32_bf16 v[132:135], a[92:95], v[40:43], v[132:135]
    v_mfma_f32_16x16x32_bf16 v[136:139], a[92:95], v[44:47], v[136:139]
    v_mfma_f32_16x16x32_bf16 v[140:143], a[92:95], v[48:51], v[140:143]
    v_mfma_f32_16x16x32_bf16 v[144:147], v[36:39], a[156:159], v[144:147]
    v_mfma_f32_16x16x32_bf16 v[148:151], v[40:43], a[156:159], v[148:151]
    v_mfma_f32_16x16x32_bf16 v[152:155], v[44:47], a[156:159], v[152:155]
    v_mfma_f32_16x16x32_bf16 v[156:159], v[48:51], a[156:159], v[156:159]
    v_mfma_f32_16x16x32_bf16 v[172:175], v[52:55], v[52:55], v[172:175]
    v_mfma_f32_16x16x32_bf16 v[176:179], v[52:55], v[180:183], v[176:179]
    ds_read_b128 v[36:39], v13 offset:512
    ds_read_b128 v[40:43], v189 offset:16896
    ds_read_b128 v[44:47], v12 offset:33280
    ds_read_b128 v[48:51], v188 offset:49664
    ds_read_b128 v[52:55], v185 offset:512
    buffer_load_dwordx4 a[60:63], v9, s[8:11], s7 offen offset:3072
    buffer_load_dwordx4 a[124:127], v9, s[8:11], s26 offen offset:3072
    buffer_load_dwordx4 a[188:191], v9, s[8:11], s27 offen offset:3072
    v_add_u32 v9, 4096, v9
    s_waitcnt vmcnt(21) lgkmcnt(5)
    v_mfma_f32_16x16x32_bf16 v[112:115], a[32:35], v[16:19], v[112:115]
    v_mfma_f32_16x16x32_bf16 v[116:119], a[32:35], v[20:23], v[116:119]
    v_mfma_f32_16x16x32_bf16 v[120:123], a[32:35], v[24:27], v[120:123]
    v_mfma_f32_16x16x32_bf16 v[124:127], a[32:35], v[28:31], v[124:127]
    v_mfma_f32_16x16x32_bf16 v[128:131], a[96:99], v[16:19], v[128:131]
    v_mfma_f32_16x16x32_bf16 v[132:135], a[96:99], v[20:23], v[132:135]
    v_mfma_f32_16x16x32_bf16 v[136:139], a[96:99], v[24:27], v[136:139]
    v_mfma_f32_16x16x32_bf16 v[140:143], a[96:99], v[28:31], v[140:143]
    v_mfma_f32_16x16x32_bf16 v[144:147], v[16:19], a[160:163], v[144:147]
    v_mfma_f32_16x16x32_bf16 v[148:151], v[20:23], a[160:163], v[148:151]
    v_mfma_f32_16x16x32_bf16 v[152:155], v[24:27], a[160:163], v[152:155]
    v_mfma_f32_16x16x32_bf16 v[156:159], v[28:31], a[160:163], v[156:159]
    v_mfma_f32_16x16x32_bf16 v[172:175], v[32:35], v[32:35], v[172:175]
    v_mfma_f32_16x16x32_bf16 v[176:179], v[32:35], v[180:183], v[176:179]
    ds_read_b128 v[16:19], v14 offset:512
    ds_read_b128 v[20:23], v190 offset:16896
    ds_read_b128 v[24:27], v15 offset:33280
    ds_read_b128 v[28:31], v191 offset:49664
    ds_read_b128 v[32:35], v186 offset:512
    s_waitcnt vmcnt(18) lgkmcnt(5)
    v_mfma_f32_16x16x32_bf16 v[112:115], a[36:39], v[36:39], v[112:115]
    v_mfma_f32_16x16x32_bf16 v[116:119], a[36:39], v[40:43], v[116:119]
    v_mfma_f32_16x16x32_bf16 v[120:123], a[36:39], v[44:47], v[120:123]
    v_mfma_f32_16x16x32_bf16 v[124:127], a[36:39], v[48:51], v[124:127]
    v_mfma_f32_16x16x32_bf16 v[128:131], a[100:103], v[36:39], v[128:131]
    v_mfma_f32_16x16x32_bf16 v[132:135], a[100:103], v[40:43], v[132:135]
    v_mfma_f32_16x16x32_bf16 v[136:139], a[100:103], v[44:47], v[136:139]
    v_mfma_f32_16x16x32_bf16 v[140:143], a[100:103], v[48:51], v[140:143]
    v_mfma_f32_16x16x32_bf16 v[144:147], v[36:39], a[164:167], v[144:147]
    v_mfma_f32_16x16x32_bf16 v[148:151], v[40:43], a[164:167], v[148:151]
    v_mfma_f32_16x16x32_bf16 v[152:155], v[44:47], a[164:167], v[152:155]
    v_mfma_f32_16x16x32_bf16 v[156:159], v[48:51], a[164:167], v[156:159]
    v_mfma_f32_16x16x32_bf16 v[172:175], v[52:55], v[52:55], v[172:175]
    v_mfma_f32_16x16x32_bf16 v[176:179], v[52:55], v[180:183], v[176:179]
    ds_read_b128 v[36:39], v15 offset:512
    ds_read_b128 v[40:43], v191 offset:16896
    ds_read_b128 v[44:47], v14 offset:33280
    ds_read_b128 v[48:51], v190 offset:49664
    ds_read_b128 v[52:55], v187 offset:512
    s_waitcnt vmcnt(15) lgkmcnt(5)
    v_mfma_f32_16x16x32_bf16 v[112:115], a[40:43], v[16:19], v[112:115]
    v_mfma_f32_16x16x32_bf16 v[116:119], a[40:43], v[20:23], v[116:119]
    v_mfma_f32_16x16x32_bf16 v[120:123], a[40:43], v[24:27], v[120:123]
    v_mfma_f32_16x16x32_bf16 v[124:127], a[40:43], v[28:31], v[124:127]
    v_mfma_f32_16x16x32_bf16 v[128:131], a[104:107], v[16:19], v[128:131]
    v_mfma_f32_16x16x32_bf16 v[132:135], a[104:107], v[20:23], v[132:135]
    v_mfma_f32_16x16x32_bf16 v[136:139], a[104:107], v[24:27], v[136:139]
    v_mfma_f32_16x16x32_bf16 v[140:143], a[104:107], v[28:31], v[140:143]
    v_mfma_f32_16x16x32_bf16 v[144:147], v[16:19], a[168:171], v[144:147]
    v_mfma_f32_16x16x32_bf16 v[148:151], v[20:23], a[168:171], v[148:151]
    v_mfma_f32_16x16x32_bf16 v[152:155], v[24:27], a[168:171], v[152:155]
    v_mfma_f32_16x16x32_bf16 v[156:159], v[28:31], a[168:171], v[156:159]
    v_mfma_f32_16x16x32_bf16 v[172:175], v[32:35], v[32:35], v[172:175]
    v_mfma_f32_16x16x32_bf16 v[176:179], v[32:35], v[180:183], v[176:179]
    ds_read_b128 v[16:19], v12 offset:768
    ds_read_b128 v[20:23], v188 offset:17152
    ds_read_b128 v[24:27], v13 offset:33536
    ds_read_b128 v[28:31], v189 offset:49920
    ds_read_b128 v[32:35], v184 offset:768
    s_waitcnt vmcnt(12) lgkmcnt(5)
    v_mfma_f32_16x16x32_bf16 v[112:115], a[44:47], v[36:39], v[112:115]
    v_mfma_f32_16x16x32_bf16 v[116:119], a[44:47], v[40:43], v[116:119]
    v_mfma_f32_16x16x32_bf16 v[120:123], a[44:47], v[44:47], v[120:123]
    v_mfma_f32_16x16x32_bf16 v[124:127], a[44:47], v[48:51], v[124:127]
    v_mfma_f32_16x16x32_bf16 v[128:131], a[108:111], v[36:39], v[128:131]
    v_mfma_f32_16x16x32_bf16 v[132:135], a[108:111], v[40:43], v[132:135]
    v_mfma_f32_16x16x32_bf16 v[136:139], a[108:111], v[44:47], v[136:139]
    v_mfma_f32_16x16x32_bf16 v[140:143], a[108:111], v[48:51], v[140:143]
    v_mfma_f32_16x16x32_bf16 v[144:147], v[36:39], a[172:175], v[144:147]
    v_mfma_f32_16x16x32_bf16 v[148:151], v[40:43], a[172:175], v[148:151]
    v_mfma_f32_16x16x32_bf16 v[152:155], v[44:47], a[172:175], v[152:155]
    v_mfma_f32_16x16x32_bf16 v[156:159], v[48:51], a[172:175], v[156:159]
    v_mfma_f32_16x16x32_bf16 v[172:175], v[52:55], v[52:55], v[172:175]
    v_mfma_f32_16x16x32_bf16 v[176:179], v[52:55], v[180:183], v[176:179]
    ds_read_b128 v[36:39], v13 offset:768
    ds_read_b128 v[40:43], v189 offset:17152
    ds_read_b128 v[44:47], v12 offset:33536
    ds_read_b128 v[48:51], v188 offset:49920
    ds_read_b128 v[52:55], v185 offset:768
    s_waitcnt vmcnt(9) lgkmcnt(5)
    v_mfma_f32_16x16x32_bf16 v[112:115], a[48:51], v[16:19], v[112:115]
    v_mfma_f32_16x16x32_bf16 v[116:119], a[48:51], v[20:23], v[116:119]
    v_mfma_f32_16x16x32_bf16 v[120:123], a[48:51], v[24:27], v[120:123]
    v_mfma_f32_16x16x32_bf16 v[124:127], a[48:51], v[28:31], v[124:127]
    v_mfma_f32_16x16x32_bf16 v[128:131], a[112:115], v[16:19], v[128:131]
    v_mfma_f32_16x16x32_bf16 v[132:135], a[112:115], v[20:23], v[132:135]
    v_mfma_f32_16x16x32_bf16 v[136:139], a[112:115], v[24:27], v[136:139]
    v_mfma_f32_16x16x32_bf16 v[140:143], a[112:115], v[28:31], v[140:143]
    v_mfma_f32_16x16x32_bf16 v[144:147], v[16:19], a[176:179], v[144:147]
    v_mfma_f32_16x16x32_bf16 v[148:151], v[20:23], a[176:179], v[148:151]
    v_mfma_f32_16x16x32_bf16 v[152:155], v[24:27], a[176:179], v[152:155]
    v_mfma_f32_16x16x32_bf16 v[156:159], v[28:31], a[176:179], v[156:159]
    v_mfma_f32_16x16x32_bf16 v[172:175], v[32:35], v[32:35], v[172:175]
    v_mfma_f32_16x16x32_bf16 v[176:179], v[32:35], v[180:183], v[176:179]
    ds_read_b128 v[16:19], v14 offset:768
    ds_read_b128 v[20:23], v190 offset:17152
    ds_read_b128 v[24:27], v15 offset:33536
    ds_read_b128 v[28:31], v191 offset:49920
    ds_read_b128 v[32:35], v186 offset:768
    s_waitcnt vmcnt(6) lgkmcnt(5)
    v_mfma_f32_16x16x32_bf16 v[112:115], a[52:55], v[36:39], v[112:115]
    v_mfma_f32_16x16x32_bf16 v[116:119], a[52:55], v[40:43], v[116:119]
    v_mfma_f32_16x16x32_bf16 v[120:123], a[52:55], v[44:47], v[120:123]
    v_mfma_f32_16x16x32_bf16 v[124:127], a[52:55], v[48:51], v[124:127]
    v_mfma_f32_16x16x32_bf16 v[128:131], a[116:119], v[36:39], v[128:131]
    v_mfma_f32_16x16x32_bf16 v[132:135], a[116:119], v[40:43], v[132:135]
    v_mfma_f32_16x16x32_bf16 v[136:139], a[116:119], v[44:47], v[136:139]
    v_mfma_f32_16x16x32_bf16 v[140:143], a[116:119], v[48:51], v[140:143]
    v_mfma_f32_16x16x32_bf16 v[144:147], v[36:39], a[180:183], v[144:147]
    v_mfma_f32_16x16x32_bf16 v[148:151], v[40:43], a[180:183], v[148:151]
    v_mfma_f32_16x16x32_bf16 v[152:155], v[44:47], a[180:183], v[152:155]
    v_mfma_f32_16x16x32_bf16 v[156:159], v[48:51], a[180:183], v[156:159]
    v_mfma_f32_16x16x32_bf16 v[172:175], v[52:55], v[52:55], v[172:175]
    v_mfma_f32_16x16x32_bf16 v[176:179], v[52:55], v[180:183], v[176:179]
    ds_read_b128 v[36:39], v15 offset:768
    ds_read_b128 v[40:43], v191 offset:17152
    ds_read_b128 v[44:47], v14 offset:33536
    ds_read_b128 v[48:51], v190 offset:49920
    ds_read_b128 v[52:55], v187 offset:768
    s_waitcnt vmcnt(3) lgkmcnt(5)
    v_mfma_f32_16x16x32_bf16 v[112:115], a[56:59], v[16:19], v[112:115]
    v_mfma_f32_16x16x32_bf16 v[116:119], a[56:59], v[20:23], v[116:119]
    v_mfma_f32_16x16x32_bf16 v[120:123], a[56:59], v[24:27], v[120:123]
    v_mfma_f32_16x16x32_bf16 v[124:127], a[56:59], v[28:31], v[124:127]
    v_mfma_f32_16x16x32_bf16 v[128:131], a[120:123], v[16:19], v[128:131]
    v_mfma_f32_16x16x32_bf16 v[132:135], a[120:123], v[20:23], v[132:135]
    v_mfma_f32_16x16x32_bf16 v[136:139], a[120:123], v[24:27], v[136:139]
    v_mfma_f32_16x16x32_bf16 v[140:143], a[120:123], v[28:31], v[140:143]
    v_mfma_f32_16x16x32_bf16 v[144:147], v[16:19], a[184:187], v[144:147]
    v_mfma_f32_16x16x32_bf16 v[148:151], v[20:23], a[184:187], v[148:151]
    v_mfma_f32_16x16x32_bf16 v[152:155], v[24:27], a[184:187], v[152:155]
    v_mfma_f32_16x16x32_bf16 v[156:159], v[28:31], a[184:187], v[156:159]
    v_mfma_f32_16x16x32_bf16 v[172:175], v[32:35], v[32:35], v[172:175]
    v_mfma_f32_16x16x32_bf16 v[176:179], v[32:35], v[180:183], v[176:179]
    s_waitcnt vmcnt(0) lgkmcnt(0)
    v_mfma_f32_16x16x32_bf16 v[112:115], a[60:63], v[36:39], v[112:115]
    v_mfma_f32_16x16x32_bf16 v[116:119], a[60:63], v[40:43], v[116:119]
    v_mfma_f32_16x16x32_bf16 v[120:123], a[60:63], v[44:47], v[120:123]
    v_mfma_f32_16x16x32_bf16 v[124:127], a[60:63], v[48:51], v[124:127]
    v_mfma_f32_16x16x32_bf16 v[128:131], a[124:127], v[36:39], v[128:131]
    v_mfma_f32_16x16x32_bf16 v[132:135], a[124:127], v[40:43], v[132:135]
    v_mfma_f32_16x16x32_bf16 v[136:139], a[124:127], v[44:47], v[136:139]
    v_mfma_f32_16x16x32_bf16 v[140:143], a[124:127], v[48:51], v[140:143]
    v_mfma_f32_16x16x32_bf16 v[144:147], v[36:39], a[188:191], v[144:147]
    v_mfma_f32_16x16x32_bf16 v[148:151], v[40:43], a[188:191], v[148:151]
    v_mfma_f32_16x16x32_bf16 v[152:155], v[44:47], a[188:191], v[152:155]
    v_mfma_f32_16x16x32_bf16 v[156:159], v[48:51], a[188:191], v[156:159]
    v_mfma_f32_16x16x32_bf16 v[172:175], v[52:55], v[52:55], v[172:175]
    v_mfma_f32_16x16x32_bf16 v[176:179], v[52:55], v[180:183], v[176:179]
    s_nop 7
    s_nop 1
    v_and_b32 v10, 3, v3
    v_mov_b32 v16, v172
    v_mov_b32 v17, v176
    v_cmp_eq_u32 vcc, 1, v10
    s_nop 1
    v_cndmask_b32 v16, v16, v173, vcc
    v_cndmask_b32 v17, v17, v177, vcc
    v_cmp_eq_u32 vcc, 2, v10
    s_nop 1
    v_cndmask_b32 v16, v16, v174, vcc
    v_cndmask_b32 v17, v17, v178, vcc
    v_cmp_eq_u32 vcc, 3, v10
    s_nop 1
    v_cndmask_b32 v16, v16, v175, vcc
    v_cndmask_b32 v17, v17, v179, vcc
    s_mov_b32 s18, 0x3b000000
    s_mov_b32 s19, 0x3727c5ac
    v_mul_f32 v17, s18, v17
    v_mul_f32 v16, s18, v16
    v_fma_f32 v16, -v17, v17, v16
    v_max_f32 v16, 0, v16
    v_cvt_pk_bf16_f32 v17, v17, v17
    v_lshlrev_b32 v17, 16, v17
    v_cvt_pk_bf16_f32 v16, v16, v16
    v_lshlrev_b32 v16, 16, v16
    v_add_f32 v16, s19, v16
    v_cvt_pk_bf16_f32 v16, v16, v16
    v_lshlrev_b32 v16, 16, v16
    v_sqrt_f32 v16, v16
    s_nop 0
    v_cvt_pk_bf16_f32 v16, v16, v16
    v_lshlrev_b32 v16, 16, v16
    v_rcp_f32 v16, v16
    s_barrier
    v_lshrrev_b32 v10, 2, v3
    v_cmp_eq_u32 vcc, v10, v4
    v_lshl_add_u32 v11, v1, 4, v3
    v_lshlrev_b32 v11, 3, v11
    s_and_saveexec_b64 s[30:31], vcc
    ds_write_b64 v11, v[16:17]
    s_mov_b64 exec, s[30:31]
    s_waitcnt lgkmcnt(0)
    s_barrier
    v_lshlrev_b32 v11, 3, v3
    ds_read_b64 v[20:21], v11 offset:0
    ds_read_b64 v[22:23], v11 offset:128
    ds_read_b64 v[24:25], v11 offset:256
    ds_read_b64 v[26:27], v11 offset:384
    v_lshlrev_b32 v12, 5, v4
    ds_read_b128 v[32:35], v12 offset:0
    ds_read_b128 v[36:39], v12 offset:16
    ds_read_b128 v[40:43], v12 offset:128
    ds_read_b128 v[44:47], v12 offset:144
    ds_read_b128 v[48:51], v12 offset:256
    ds_read_b128 v[52:55], v12 offset:272
    ds_read_b128 v[56:59], v12 offset:384
    ds_read_b128 v[60:63], v12 offset:400
    s_waitcnt lgkmcnt(8)
    s_lshl_b32 s16, s5, 6
    v_add_u32 v10, s16, v3
    s_lshl_b32 s23, s6, 16
    s_add_u32 s23, s23, 16777216
    s_add_u32 s24, s23, 2097152
    s_lshl_b32 s25, s5, 11
    s_add_u32 s25, s25, s23
    s_add_u32 s25, s25, 4194304
    v_lshlrev_b32 v11, 5, v10
    v_lshl_add_u32 v11, v4, 3, v11
    v_fma_f32 v112, -v21, v160, v112
    v_mul_f32 v112, v112, v20
    v_fma_f32 v113, -v21, v161, v113
    v_mul_f32 v113, v113, v20
    v_fma_f32 v114, -v21, v162, v114
    v_mul_f32 v114, v114, v20
    v_fma_f32 v115, -v21, v163, v115
    v_mul_f32 v115, v115, v20
    v_cvt_pk_bf16_f32 v112, v112, v113
    v_cvt_pk_bf16_f32 v113, v114, v115
    buffer_store_dwordx2 v[112:113], v11, s[8:11], s23 offen offset:0
    v_fma_f32 v116, -v23, v160, v116
    v_mul_f32 v116, v116, v22
    v_fma_f32 v117, -v23, v161, v117
    v_mul_f32 v117, v117, v22
    v_fma_f32 v118, -v23, v162, v118
    v_mul_f32 v118, v118, v22
    v_fma_f32 v119, -v23, v163, v119
    v_mul_f32 v119, v119, v22
    v_cvt_pk_bf16_f32 v116, v116, v117
    v_cvt_pk_bf16_f32 v117, v118, v119
    buffer_store_dwordx2 v[116:117], v11, s[8:11], s23 offen offset:512
    v_fma_f32 v120, -v25, v160, v120
    v_mul_f32 v120, v120, v24
    v_fma_f32 v121, -v25, v161, v121
    v_mul_f32 v121, v121, v24
    v_fma_f32 v122, -v25, v162, v122
    v_mul_f32 v122, v122, v24
    v_fma_f32 v123, -v25, v163, v123
    v_mul_f32 v123, v123, v24
    v_cvt_pk_bf16_f32 v120, v120, v121
    v_cvt_pk_bf16_f32 v121, v122, v123
    buffer_store_dwordx2 v[120:121], v11, s[8:11], s23 offen offset:1024
    v_fma_f32 v124, -v27, v160, v124
    v_mul_f32 v124, v124, v26
    v_fma_f32 v125, -v27, v161, v125
    v_mul_f32 v125, v125, v26
    v_fma_f32 v126, -v27, v162, v126
    v_mul_f32 v126, v126, v26
    v_fma_f32 v127, -v27, v163, v127
    v_mul_f32 v127, v127, v26
    v_cvt_pk_bf16_f32 v124, v124, v125
    v_cvt_pk_bf16_f32 v125, v126, v127
    buffer_store_dwordx2 v[124:125], v11, s[8:11], s23 offen offset:1536
    v_fma_f32 v128, -v21, v164, v128
    v_mul_f32 v128, v128, v20
    v_fma_f32 v129, -v21, v165, v129
    v_mul_f32 v129, v129, v20
    v_fma_f32 v130, -v21, v166, v130
    v_mul_f32 v130, v130, v20
    v_fma_f32 v131, -v21, v167, v131
    v_mul_f32 v131, v131, v20
    v_cvt_pk_bf16_f32 v128, v128, v129
    v_cvt_pk_bf16_f32 v129, v130, v131
    buffer_store_dwordx2 v[128:129], v11, s[8:11], s24 offen offset:0
    v_fma_f32 v132, -v23, v164, v132
    v_mul_f32 v132, v132, v22
    v_fma_f32 v133, -v23, v165, v133
    v_mul_f32 v133, v133, v22
    v_fma_f32 v134, -v23, v166, v134
    v_mul_f32 v134, v134, v22
    v_fma_f32 v135, -v23, v167, v135
    v_mul_f32 v135, v135, v22
    v_cvt_pk_bf16_f32 v132, v132, v133
    v_cvt_pk_bf16_f32 v133, v134, v135
    buffer_store_dwordx2 v[132:133], v11, s[8:11], s24 offen offset:512
    v_fma_f32 v136, -v25, v164, v136
    v_mul_f32 v136, v136, v24
    v_fma_f32 v137, -v25, v165, v137
    v_mul_f32 v137, v137, v24
    v_fma_f32 v138, -v25, v166, v138
    v_mul_f32 v138, v138, v24
    v_fma_f32 v139, -v25, v167, v139
    v_mul_f32 v139, v139, v24
    v_cvt_pk_bf16_f32 v136, v136, v137
    v_cvt_pk_bf16_f32 v137, v138, v139
    buffer_store_dwordx2 v[136:137], v11, s[8:11], s24 offen offset:1024
    v_fma_f32 v140, -v27, v164, v140
    v_mul_f32 v140, v140, v26
    v_fma_f32 v141, -v27, v165, v141
    v_mul_f32 v141, v141, v26
    v_fma_f32 v142, -v27, v166, v142
    v_mul_f32 v142, v142, v26
    v_fma_f32 v143, -v27, v167, v143
    v_mul_f32 v143, v143, v26
    v_cvt_pk_bf16_f32 v140, v140, v141
    v_cvt_pk_bf16_f32 v141, v142, v143
    buffer_store_dwordx2 v[140:141], v11, s[8:11], s24 offen offset:1536
    v_lshrrev_b32 v11, 1, v4
    v_lshlrev_b32 v11, 8, v11
    v_lshl_add_u32 v11, v3, 4, v11
    v_and_b32 v12, 1, v4
    v_lshl_add_u32 v11, v12, 3, v11
    s_waitcnt lgkmcnt(0)
    v_fma_f32 v144, -v33, v168, v144
    v_mul_f32 v144, v144, v32
    v_fma_f32 v145, -v35, v168, v145
    v_mul_f32 v145, v145, v34
    v_fma_f32 v146, -v37, v168, v146
    v_mul_f32 v146, v146, v36
    v_fma_f32 v147, -v39, v168, v147
    v_mul_f32 v147, v147, v38
    v_cvt_pk_bf16_f32 v144, v144, v145
    v_cvt_pk_bf16_f32 v145, v146, v147
    buffer_store_dwordx2 v[144:145], v11, s[8:11], s25 offen offset:0
    v_fma_f32 v148, -v41, v168, v148
    v_mul_f32 v148, v148, v40
    v_fma_f32 v149, -v43, v168, v149
    v_mul_f32 v149, v149, v42
    v_fma_f32 v150, -v45, v168, v150
    v_mul_f32 v150, v150, v44
    v_fma_f32 v151, -v47, v168, v151
    v_mul_f32 v151, v151, v46
    v_cvt_pk_bf16_f32 v148, v148, v149
    v_cvt_pk_bf16_f32 v149, v150, v151
    buffer_store_dwordx2 v[148:149], v11, s[8:11], s25 offen offset:512
    v_fma_f32 v152, -v49, v168, v152
    v_mul_f32 v152, v152, v48
    v_fma_f32 v153, -v51, v168, v153
    v_mul_f32 v153, v153, v50
    v_fma_f32 v154, -v53, v168, v154
    v_mul_f32 v154, v154, v52
    v_fma_f32 v155, -v55, v168, v155
    v_mul_f32 v155, v155, v54
    v_cvt_pk_bf16_f32 v152, v152, v153
    v_cvt_pk_bf16_f32 v153, v154, v155
    buffer_store_dwordx2 v[152:153], v11, s[8:11], s25 offen offset:1024
    v_fma_f32 v156, -v57, v168, v156
    v_mul_f32 v156, v156, v56
    v_fma_f32 v157, -v59, v168, v157
    v_mul_f32 v157, v157, v58
    v_fma_f32 v158, -v61, v168, v158
    v_mul_f32 v158, v158, v60
    v_fma_f32 v159, -v63, v168, v159
    v_mul_f32 v159, v159, v62
    v_cvt_pk_bf16_f32 v156, v156, v157
    v_cvt_pk_bf16_f32 v157, v158, v159
    buffer_store_dwordx2 v[156:157], v11, s[8:11], s25 offen offset:1536
L_end_qkv2_kernel:
    s_endpgm
.section .rodata,"a"
.p2align 6
.amdhsa_kernel qkv2_kernel
  .amdhsa_next_free_vgpr 384
  .amdhsa_next_free_sgpr 96
  .amdhsa_accum_offset 192
  .amdhsa_group_segment_fixed_size 0
  .amdhsa_kernarg_size 120
  .amdhsa_user_sgpr_count 2
  .amdhsa_user_sgpr_kernarg_segment_ptr 1
  .amdhsa_system_sgpr_workgroup_id_x 1
.end_amdhsa_kernel
.text

.globl attn_kernel
.p2align 8
.type attn_kernel,@function
attn_kernel:
    s_cmp_ge_u32 s2, 512
    s_cbranch_scc1 L_end_attn_kernel
    s_load_dwordx2 s[8:9], s[0:1], 112
    s_mov_b32 s10, 25165824
    s_mov_b32 s11, 0x00020000
    v_lshrrev_b32 v1, 6, v0
    v_and_b32 v2, 31, v0
    v_bfe_u32 v3, v0, 5, 1
    s_nop 0
    v_readfirstlane_b32 s4, v1
    s_lshr_b32 s5, s2, 5
    s_lshl_b32 s5, s5, 2
    s_add_u32 s5, s5, s4
    s_lshl_b32 s5, s5, 5
    s_and_b32 s6, s2, 7
    s_lshl_b32 s6, s6, 2
    s_bfe_u32 s7, s2, 0x20003
    s_add_u32 s6, s6, s7
    s_lshl_b32 s7, s6, 16
    s_add_u32 s16, s7, 16777216
    s_add_u32 s17, s7, 18874368
    s_add_u32 s18, s7, 20971520
    s_waitcnt lgkmcnt(0)
    v_add_u32 v4, s5, v2
    v_lshlrev_b32 v4, 5, v4
    v_lshl_add_u32 v4, v3, 4, v4
    buffer_load_dwordx4 v[8:11], v4, s[8:11], s16 offen
    v_and_b32 v5, 0x13, v2
    v_bfe_u32 v6, v2, 2, 1
    v_lshl_add_u32 v5, v6, 3, v5
    v_bfe_u32 v6, v2, 3, 1
    v_lshl_add_u32 v5, v6, 2, v5
    s_sub_u32 s19, s5, 256
    v_add_u32 v5, s19, v5
    v_lshlrev_b32 v5, 5, v5
    v_lshl_add_u32 v5, v3, 4, v5
    v_add_u32 v5, s17, v5
    s_mov_b32 s24, 0
    s_mov_b32 s25, 4096
    s_mov_b32 s26, 8192
    buffer_load_dwordx4 v[12:15], v5, s[8:11], s24 offen offset:0
    buffer_load_dwordx4 v[16:19], v5, s[8:11], s24 offen offset:1024
    buffer_load_dwordx4 v[20:23], v5, s[8:11], s24 offen offset:2048
    buffer_load_dwordx4 v[24:27], v5, s[8:11], s24 offen offset:3072
    buffer_load_dwordx4 v[28:31], v5, s[8:11], s25 offen offset:0
    buffer_load_dwordx4 v[32:35], v5, s[8:11], s25 offen offset:1024
    buffer_load_dwordx4 v[36:39], v5, s[8:11], s25 offen offset:2048
    buffer_load_dwordx4 v[40:43], v5, s[8:11], s25 offen offset:3072
    buffer_load_dwordx4 v[44:47], v5, s[8:11], s26 offen offset:0
    v_and_b32 v6, 27, v2
    v_cmp_eq_u32 vcc, 16, v6
    v_mov_b32 v6, 0x3f803f80
    s_nop 0
    v_cndmask_b32 v6, 0, v6, vcc
    v_accvgpr_write_b32 a0, v6
    v_accvgpr_write_b32 a1, v6
    v_accvgpr_write_b32 a2, v6
    v_accvgpr_write_b32 a3, v6
    v_accvgpr_write_b32 a4, v6
    v_accvgpr_write_b32 a5, v6
    v_accvgpr_write_b32 a6, v6
    v_accvgpr_write_b32 a7, v6
    v_accvgpr_write_b32 a8, v6
    v_accvgpr_write_b32 a9, v6
    v_accvgpr_write_b32 a10, v6
    v_accvgpr_write_b32 a11, v6
    v_accvgpr_write_b32 a12, v6
    v_accvgpr_write_b32 a13, v6
    v_accvgpr_write_b32 a14, v6
    v_accvgpr_write_b32 a15, v6
    v_accvgpr_write_b32 a16, v6
    v_accvgpr_write_b32 a17, v6
    v_accvgpr_write_b32 a18, v6
    v_accvgpr_write_b32 a19, v6
    v_accvgpr_write_b32 a20, v6
    v_accvgpr_write_b32 a21, v6
    v_accvgpr_write_b32 a22, v6
    v_accvgpr_write_b32 a23, v6
    v_accvgpr_write_b32 a24, v6
    v_accvgpr_write_b32 a25, v6
    v_accvgpr_write_b32 a26, v6
    v_accvgpr_write_b32 a27, v6
    v_accvgpr_write_b32 a28, v6
    v_accvgpr_write_b32 a29, v6
    v_accvgpr_write_b32 a30, v6
    v_accvgpr_write_b32 a31, v6
    v_accvgpr_write_b32 a32, v6
    v_accvgpr_write_b32 a33, v6
    v_accvgpr_write_b32 a34, v6
    v_accvgpr_write_b32 a35, v6
    v_mov_b32 v1, v6
    v_lshlrev_b32 v6, 4, v2
    v_lshl_add_u32 v6, v3, 8, v6
    s_lshl_b32 s19, s19, 5
    v_add_u32 v6, s19, v6
    v_add_u32 v6, s18, v6
    v_cmp_gt_u32 vcc, 16, v2
    s_and_saveexec_b64 s[30:31], vcc
    buffer_load_dwordx4 a[0:3], v6, s[8:11], s24 offen offset:0
    buffer_load_dwordx4 a[4:7], v6, s[8:11], s24 offen offset:512
    buffer_load_dwordx4 a[8:11], v6, s[8:11], s24 offen offset:1024
    buffer_load_dwordx4 a[12:15], v6, s[8:11], s24 offen offset:1536
    buffer_load_dwordx4 a[16:19], v6, s[8:11], s24 offen offset:2048
    buffer_load_dwordx4 a[20:23], v6, s[8:11], s24 offen offset:2560
    buffer_load_dwordx4 a[24:27], v6, s[8:11], s24 offen offset:3072
    buffer_load_dwordx4 a[28:31], v6, s[8:11], s24 offen offset:3584
    buffer_load_dwordx4 a[32:35], v6, s[8:11], s25 offen offset:0
    s_mov_b64 s[34:35], exec
    s_mov_b64 exec, s[30:31]
    v_mov_b32 v0, v6
    s_waitcnt vmcnt(9)
    v_mfma_f32_32x32x16_bf16 v[48:63], v[12:15], v[8:11], 0
    v_mfma_f32_32x32x16_bf16 v[64:79], v[16:19], v[8:11], 0
    v_mfma_f32_32x32x16_bf16 v[80:95], v[20:23], v[8:11], 0
    v_mfma_f32_32x32x16_bf16 v[96:111], v[24:27], v[8:11], 0
    v_mfma_f32_32x32x16_bf16 v[112:127], v[28:31], v[8:11], 0
    v_mfma_f32_32x32x16_bf16 v[128:143], v[32:35], v[8:11], 0
    v_mfma_f32_32x32x16_bf16 v[144:159], v[36:39], v[8:11], 0
    v_mfma_f32_32x32x16_bf16 v[160:175], v[40:43], v[8:11], 0
    v_mfma_f32_32x32x16_bf16 v[176:191], v[44:47], v[8:11], 0
    s_nop 7
    s_nop 7
    v_mov_b32 v12, v1
    v_mov_b32 v13, v1
    v_mov_b32 v14, v1
    v_mov_b32 v15, v1
    v_mov_b32 v16, v1
    v_mov_b32 v17, v1
    v_mov_b32 v18, v1
    v_mov_b32 v19, v1
    v_mov_b32 v20, v1
    v_mov_b32 v21, v1
    v_mov_b32 v22, v1
    v_mov_b32 v23, v1
    v_mov_b32 v24, v1
    v_mov_b32 v25, v1
    v_mov_b32 v26, v1
    v_mov_b32 v27, v1
    v_mov_b32 v28, v1
    v_mov_b32 v29, v1
    v_mov_b32 v30, v1
    v_mov_b32 v31, v1
    v_mov_b32 v32, v1
    v_mov_b32 v33, v1
    v_mov_b32 v34, v1
    v_mov_b32 v35, v1
    v_mov_b32 v36, v1
    v_mov_b32 v37, v1
    v_mov_b32 v38, v1
    v_mov_b32 v39, v1
    v_mov_b32 v40, v1
    v_mov_b32 v41, v1
    v_mov_b32 v42, v1
    v_mov_b32 v43, v1
    v_mov_b32 v44, v1
    v_mov_b32 v45, v1
    v_mov_b32 v46, v1
    v_mov_b32 v47, v1
    s_mov_b64 exec, s[34:35]
    buffer_load_dwordx4 v[12:15], v0, s[8:11], s25 offen offset:512
    buffer_load_dwordx4 v[16:19], v0, s[8:11], s25 offen offset:1024
    buffer_load_dwordx4 v[20:23], v0, s[8:11], s25 offen offset:1536
    buffer_load_dwordx4 v[24:27], v0, s[8:11], s25 offen offset:2048
    buffer_load_dwordx4 v[28:31], v0, s[8:11], s25 offen offset:2560
    buffer_load_dwordx4 v[32:35], v0, s[8:11], s25 offen offset:3072
    buffer_load_dwordx4 v[36:39], v0, s[8:11], s25 offen offset:3584
    buffer_load_dwordx4 v[40:43], v0, s[8:11], s26 offen offset:0
    buffer_load_dwordx4 v[44:47], v0, s[8:11], s26 offen offset:512
    s_mov_b64 exec, s[30:31]
    v_mov_b32 v7, 0xf149f2ca
    v_lshlrev_b32 v6, 3, v3
    v_sub_u32 v6, v2, v6
    v_cmp_lt_i32 vcc, v6, 0
    v_cmp_ge_i32 s[32:33], v6, 0
    s_nop 0
    v_cndmask_b32 v48, v7, v48, vcc
    v_cndmask_b32 v176, v7, v176, s[32:33]
    v_cmp_lt_i32 vcc, v6, 1
    v_cmp_ge_i32 s[32:33], v6, 1
    s_nop 0
    v_cndmask_b32 v49, v7, v49, vcc
    v_cndmask_b32 v177, v7, v177, s[32:33]
    v_cmp_lt_i32 vcc, v6, 2
    v_cmp_ge_i32 s[32:33], v6, 2
    s_nop 0
    v_cndmask_b32 v50, v7, v50, vcc
    v_cndmask_b32 v178, v7, v178, s[32:33]
    v_cmp_lt_i32 vcc, v6, 3
    v_cmp_ge_i32 s[32:33], v6, 3
    s_nop 0
    v_cndmask_b32 v51, v7, v51, vcc
    v_cndmask_b32 v179, v7, v179, s[32:33]
    v_cmp_lt_i32 vcc, v6, 4
    v_cmp_ge_i32 s[32:33], v6, 4
    s_nop 0
    v_cndmask_b32 v52, v7, v52, vcc
    v_cndmask_b32 v180, v7, v180, s[32:33]
    v_cmp_lt_i32 vcc, v6, 5
    v_cmp_ge_i32 s[32:33], v6, 5
    s_nop 0
    v_cndmask_b32 v53, v7, v53, vcc
    v_cndmask_b32 v181, v7, v181, s[32:33]
    v_cmp_lt_i32 vcc, v6, 6
    v_cmp_ge_i32 s[32:33], v6, 6
    s_nop 0
    v_cndmask_b32 v54, v7, v54, vcc
    v_cndmask_b32 v182, v7, v182, s[32:33]
    v_cmp_lt_i32 vcc, v6, 7
    v_cmp_ge_i32 s[32:33], v6, 7
    s_nop 0
    v_cndmask_b32 v55, v7, v55, vcc
    v_cndmask_b32 v183, v7, v183, s[32:33]
    v_cmp_lt_i32 vcc, v6, 16
    v_cmp_ge_i32 s[32:33], v6, 16
    s_nop 0
    v_cndmask_b32 v56, v7, v56, vcc
    v_cndmask_b32 v184, v7, v184, s[32:33]
    v_cmp_lt_i32 vcc, v6, 17
    v_cmp_ge_i32 s[32:33], v6, 17
    s_nop 0
    v_cndmask_b32 v57, v7, v57, vcc
    v_cndmask_b32 v185, v7, v185, s[32:33]
    v_cmp_lt_i32 vcc, v6, 18
    v_cmp_ge_i32 s[32:33], v6, 18
    s_nop 0
    v_cndmask_b32 v58, v7, v58, vcc
    v_cndmask_b32 v186, v7, v186, s[32:33]
    v_cmp_lt_i32 vcc, v6, 19
    v_cmp_ge_i32 s[32:33], v6, 19
    s_nop 0
    v_cndmask_b32 v59, v7, v59, vcc
    v_cndmask_b32 v187, v7, v187, s[32:33]
    v_cmp_lt_i32 vcc, v6, 20
    v_cmp_ge_i32 s[32:33], v6, 20
    s_nop 0
    v_cndmask_b32 v60, v7, v60, vcc
    v_cndmask_b32 v188, v7, v188, s[32:33]
    v_cmp_lt_i32 vcc, v6, 21
    v_cmp_ge_i32 s[32:33], v6, 21
    s_nop 0
    v_cndmask_b32 v61, v7, v61, vcc
    v_cndmask_b32 v189, v7, v189, s[32:33]
    v_cmp_lt_i32 vcc, v6, 22
    v_cmp_ge_i32 s[32:33], v6, 22
    s_nop 0
    v_cndmask_b32 v62, v7, v62, vcc
    v_cndmask_b32 v190, v7, v190, s[32:33]
    v_cmp_lt_i32 vcc, v6, 23
    v_cmp_ge_i32 s[32:33], v6, 23
    s_nop 0
    v_cndmask_b32 v63, v7, v63, vcc
    v_cndmask_b32 v191, v7, v191, s[32:33]
    s_cmp_ge_u32 s5, 256
    s_cbranch_scc1 L_mk_done
    v_mov_b32 v48, v7
    v_mov_b32 v49, v7
    v_mov_b32 v50, v7
    v_mov_b32 v51, v7
    v_mov_b32 v52, v7
    v_mov_b32 v53, v7
    v_mov_b32 v54, v7
    v_mov_b32 v55, v7
    v_mov_b32 v56, v7
    v_mov_b32 v57, v7
    v_mov_b32 v58, v7
    v_mov_b32 v59, v7
    v_mov_b32 v60, v7
    v_mov_b32 v61, v7
    v_mov_b32 v62, v7
    v_mov_b32 v63, v7
    s_cmp_ge_u32 s5, 224
    s_cbranch_scc1 L_mk_done
    v_mov_b32 v64, v7
    v_mov_b32 v65, v7
    v_mov_b32 v66, v7
    v_mov_b32 v67, v7
    v_mov_b32 v68, v7
    v_mov_b32 v69, v7
    v_mov_b32 v70, v7
    v_mov_b32 v71, v7
    v_mov_b32 v72, v7
    v_mov_b32 v73, v7
    v_mov_b32 v74, v7
    v_mov_b32 v75, v7
    v_mov_b32 v76, v7
    v_mov_b32 v77, v7
    v_mov_b32 v78, v7
    v_mov_b32 v79, v7
    s_cmp_ge_u32 s5, 192
    s_cbranch_scc1 L_mk_done
    v_mov_b32 v80, v7
    v_mov_b32 v81, v7
    v_mov_b32 v82, v7
    v_mov_b32 v83, v7
    v_mov_b32 v84, v7
    v_mov_b32 v85, v7
    v_mov_b32 v86, v7
    v_mov_b32 v87, v7
    v_mov_b32 v88, v7
    v_mov_b32 v89, v7
    v_mov_b32 v90, v7
    v_mov_b32 v91, v7
    v_mov_b32 v92, v7
    v_mov_b32 v93, v7
    v_mov_b32 v94, v7
    v_mov_b32 v95, v7
    s_cmp_ge_u32 s5, 160
    s_cbranch_scc1 L_mk_done
    v_mov_b32 v96, v7
    v_mov_b32 v97, v7
    v_mov_b32 v98, v7
    v_mov_b32 v99, v7
    v_mov_b32 v100, v7
    v_mov_b32 v101, v7
    v_mov_b32 v102, v7
    v_mov_b32 v103, v7
    v_mov_b32 v104, v7
    v_mov_b32 v105, v7
    v_mov_b32 v106, v7
    v_mov_b32 v107, v7
    v_mov_b32 v108, v7
    v_mov_b32 v109, v7
    v_mov_b32 v110, v7
    v_mov_b32 v111, v7
    s_cmp_ge_u32 s5, 128
    s_cbranch_scc1 L_mk_done
    v_mov_b32 v112, v7
    v_mov_b32 v113, v7
    v_mov_b32 v114, v7
    v_mov_b32 v115, v7
    v_mov_b32 v116, v7
    v_mov_b32 v117, v7
    v_mov_b32 v118, v7
    v_mov_b32 v119, v7
    v_mov_b32 v120, v7
    v_mov_b32 v121, v7
    v_mov_b32 v122, v7
    v_mov_b32 v123, v7
    v_mov_b32 v124, v7
    v_mov_b32 v125, v7
    v_mov_b32 v126, v7
    v_mov_b32 v127, v7
    s_cmp_ge_u32 s5, 96
    s_cbranch_scc1 L_mk_done
    v_mov_b32 v128, v7
    v_mov_b32 v129, v7
    v_mov_b32 v130, v7
    v_mov_b32 v131, v7
    v_mov_b32 v132, v7
    v_mov_b32 v133, v7
    v_mov_b32 v134, v7
    v_mov_b32 v135, v7
    v_mov_b32 v136, v7
    v_mov_b32 v137, v7
    v_mov_b32 v138, v7
    v_mov_b32 v139, v7
    v_mov_b32 v140, v7
    v_mov_b32 v141, v7
    v_mov_b32 v142, v7
    v_mov_b32 v143, v7
    s_cmp_ge_u32 s5, 64
    s_cbranch_scc1 L_mk_done
    v_mov_b32 v144, v7
    v_mov_b32 v145, v7
    v_mov_b32 v146, v7
    v_mov_b32 v147, v7
    v_mov_b32 v148, v7
    v_mov_b32 v149, v7
    v_mov_b32 v150, v7
    v_mov_b32 v151, v7
    v_mov_b32 v152, v7
    v_mov_b32 v153, v7
    v_mov_b32 v154, v7
    v_mov_b32 v155, v7
    v_mov_b32 v156, v7
    v_mov_b32 v157, v7
    v_mov_b32 v158, v7
    v_mov_b32 v159, v7
    s_cmp_ge_u32 s5, 32
    s_cbranch_scc1 L_mk_done
    v_mov_b32 v160, v7
    v_mov_b32 v161, v7
    v_mov_b32 v162, v7
    v_mov_b32 v163, v7
    v_mov_b32 v164, v7
    v_mov_b32 v165, v7
    v_mov_b32 v166, v7
    v_mov_b32 v167, v7
    v_mov_b32 v168, v7
    v_mov_b32 v169, v7
    v_mov_b32 v170, v7
    v_mov_b32 v171, v7
    v_mov_b32 v172, v7
    v_mov_b32 v173, v7
    v_mov_b32 v174, v7
    v_mov_b32 v175, v7
L_mk_done:
    v_max_f32 v4, v48, v49
    v_max3_f32 v4, v4, v50, v51
    v_max3_f32 v4, v4, v52, v53
    v_max3_f32 v4, v4, v54, v55
    v_max3_f32 v4, v4, v56, v57
    v_max3_f32 v4, v4, v58, v59
    v_max3_f32 v4, v4, v60, v61
    v_max3_f32 v4, v4, v62, v63
    v_max3_f32 v4, v4, v64, v65
    v_max3_f32 v4, v4, v66, v67
    v_max3_f32 v4, v4, v68, v69
    v_max3_f32 v4, v4, v70, v71
    v_max3_f32 v4, v4, v72, v73
    v_max3_f32 v4, v4, v74, v75
    v_max3_f32 v4, v4, v76, v77
    v_max3_f32 v4, v4, v78, v79
    v_max3_f32 v4, v4, v80, v81
    v_max3_f32 v4, v4, v82, v83
    v_max3_f32 v4, v4, v84, v85
    v_max3_f32 v4, v4, v86, v87
    v_max3_f32 v4, v4, v88, v89
    v_max3_f32 v4, v4, v90, v91
    v_max3_f32 v4, v4, v92, v93
    v_max3_f32 v4, v4, v94, v95
    v_max3_f32 v4, v4, v96, v97
    v_max3_f32 v4, v4, v98, v99
    v_max3_f32 v4, v4, v100, v101
    v_max3_f32 v4, v4, v102, v103
    v_max3_f32 v4, v4, v104, v105
    v_max3_f32 v4, v4, v106, v107
    v_max3_f32 v4, v4, v108, v109
    v_max3_f32 v4, v4, v110, v111
    v_max3_f32 v4, v4, v112, v113
    v_max3_f32 v4, v4, v114, v115
    v_max3_f32 v4, v4, v116, v117
    v_max3_f32 v4, v4, v118, v119
    v_max3_f32 v4, v4, v120, v121
    v_max3_f32 v4, v4, v122, v123
    v_max3_f32 v4, v4, v124, v125
    v_max3_f32 v4, v4, v126, v127
    v_max3_f32 v4, v4, v128, v129
    v_max3_f32 v4, v4, v130, v131
    v_max3_f32 v4, v4, v132, v133
    v_max3_f32 v4, v4, v134, v135
    v_max3_f32 v4, v4, v136, v137
    v_max3_f32 v4, v4, v138, v139
    v_max3_f32 v4, v4, v140, v141
    v_max3_f32 v4, v4, v142, v143
    v_max3_f32 v4, v4, v144, v145
    v_max3_f32 v4, v4, v146, v147
    v_max3_f32 v4, v4, v148, v149
    v_max3_f32 v4, v4, v150, v151
    v_max3_f32 v4, v4, v152, v153
    v_max3_f32 v4, v4, v154, v155
    v_max3_f32 v4, v4, v156, v157
    v_max3_f32 v4, v4, v158, v159
    v_max3_f32 v4, v4, v160, v161
    v_max3_f32 v4, v4, v162, v163
    v_max3_f32 v4, v4, v164, v165
    v_max3_f32 v4, v4, v166, v167
    v_max3_f32 v4, v4, v168, v169
    v_max3_f32 v4, v4, v170, v171
    v_max3_f32 v4, v4, v172, v173
    v_max3_f32 v4, v4, v174, v175
    v_max3_f32 v4, v4, v176, v177
    v_max3_f32 v4, v4, v178, v179
    v_max3_f32 v4, v4, v180, v181
    v_max3_f32 v4, v4, v182, v183
    v_max3_f32 v4, v4, v184, v185
    v_max3_f32 v4, v4, v186, v187
    v_max3_f32 v4, v4, v188, v189
    v_max3_f32 v4, v4, v190, v191
    v_xor_b32 v5, 1, v3
    v_lshl_add_u32 v5, v5, 5, v2
    v_lshlrev_b32 v5, 2, v5
    ds_bpermute_b32 v6, v5, v4
    s_mov_b32 s20, 0x3eb8aa3b
    s_waitcnt lgkmcnt(0)
    v_max_f32 v4, v4, v6
    v_mul_f32 v4, s20, v4
    s_waitcnt vmcnt(9)
    v_fma_f32 v48, v48, s20, -v4
    v_fma_f32 v49, v49, s20, -v4
    v_fma_f32 v50, v50, s20, -v4
    v_fma_f32 v51, v51, s20, -v4
    v_fma_f32 v52, v52, s20, -v4
    v_fma_f32 v53, v53, s20, -v4
    v_fma_f32 v54, v54, s20, -v4
    v_fma_f32 v55, v55, s20, -v4
    v_exp_f32 v48, v48
    v_exp_f32 v49, v49
    v_exp_f32 v50, v50
    v_exp_f32 v51, v51
    v_exp_f32 v52, v52
    v_exp_f32 v53, v53
    v_exp_f32 v54, v54
    v_exp_f32 v55, v55
    s_nop 0
    v_cvt_pk_bf16_f32 v48, v48, v49
    v_cvt_pk_bf16_f32 v49, v50, v51
    v_cvt_pk_bf16_f32 v50, v52, v53
    v_cvt_pk_bf16_f32 v51, v54, v55
    s_nop 1
    v_mfma_f32_32x32x16_bf16 v[192:207], a[0:3], v[48:51], 0
    v_fma_f32 v56, v56, s20, -v4
    v_fma_f32 v57, v57, s20, -v4
    v_fma_f32 v58, v58, s20, -v4
    v_fma_f32 v59, v59, s20, -v4
    v_fma_f32 v60, v60, s20, -v4
    v_fma_f32 v61, v61, s20, -v4
    v_fma_f32 v62, v62, s20, -v4
    v_fma_f32 v63, v63, s20, -v4
    v_exp_f32 v56, v56
    v_exp_f32 v57, v57
    v_exp_f32 v58, v58
    v_exp_f32 v59, v59
    v_exp_f32 v60, v60
    v_exp_f32 v61, v61
    v_exp_f32 v62, v62
    v_exp_f32 v63, v63
    s_nop 0
    v_cvt_pk_bf16_f32 v56, v56, v57
    v_cvt_pk_bf16_f32 v57, v58, v59
    v_cvt_pk_bf16_f32 v58, v60, v61
    v_cvt_pk_bf16_f32 v59, v62, v63
    s_nop 1
    v_mfma_f32_32x32x16_bf16 v[192:207], a[4:7], v[56:59], v[192:207]
    v_fma_f32 v64, v64, s20, -v4
    v_fma_f32 v65, v65, s20, -v4
    v_fma_f32 v66, v66, s20, -v4
    v_fma_f32 v67, v67, s20, -v4
    v_fma_f32 v68, v68, s20, -v4
    v_fma_f32 v69, v69, s20, -v4
    v_fma_f32 v70, v70, s20, -v4
    v_fma_f32 v71, v71, s20, -v4
    v_exp_f32 v64, v64
    v_exp_f32 v65, v65
    v_exp_f32 v66, v66
    v_exp_f32 v67, v67
    v_exp_f32 v68, v68
    v_exp_f32 v69, v69
    v_exp_f32 v70, v70
    v_exp_f32 v71, v71
    s_nop 0
    v_cvt_pk_bf16_f32 v64, v64, v65
    v_cvt_pk_bf16_f32 v65, v66, v67
    v_cvt_pk_bf16_f32 v66, v68, v69
    v_cvt_pk_bf16_f32 v67, v70, v71
    s_nop 1
    v_mfma_f32_32x32x16_bf16 v[192:207], a[8:11], v[64:67], v[192:207]
    v_fma_f32 v72, v72, s20, -v4
    v_fma_f32 v73, v73, s20, -v4
    v_fma_f32 v74, v74, s20, -v4
    v_fma_f32 v75, v75, s20, -v4
    v_fma_f32 v76, v76, s20, -v4
    v_fma_f32 v77, v77, s20, -v4
    v_fma_f32 v78, v78, s20, -v4
    v_fma_f32 v79, v79, s20, -v4
    v_exp_f32 v72, v72
    v_exp_f32 v73, v73
    v_exp_f32 v74, v74
    v_exp_f32 v75, v75
    v_exp_f32 v76, v76
    v_exp_f32 v77, v77
    v_exp_f32 v78, v78
    v_exp_f32 v79, v79
    s_nop 0
    v_cvt_pk_bf16_f32 v72, v72, v73
    v_cvt_pk_bf16_f32 v73, v74, v75
    v_cvt_pk_bf16_f32 v74, v76, v77
    v_cvt_pk_bf16_f32 v75, v78, v79
    s_nop 1
    v_mfma_f32_32x32x16_bf16 v[192:207], a[12:15], v[72:75], v[192:207]
    v_fma_f32 v80, v80, s20, -v4
    v_fma_f32 v81, v81, s20, -v4
    v_fma_f32 v82, v82, s20, -v4
    v_fma_f32 v83, v83, s20, -v4
    v_fma_f32 v84, v84, s20, -v4
    v_fma_f32 v85, v85, s20, -v4
    v_fma_f32 v86, v86, s20, -v4
    v_fma_f32 v87, v87, s20, -v4
    v_exp_f32 v80, v80
    v_exp_f32 v81, v81
    v_exp_f32 v82, v82
    v_exp_f32 v83, v83
    v_exp_f32 v84, v84
    v_exp_f32 v85, v85
    v_exp_f32 v86, v86
    v_exp_f32 v87, v87
    s_nop 0
    v_cvt_pk_bf16_f32 v80, v80, v81
    v_cvt_pk_bf16_f32 v81, v82, v83
    v_cvt_pk_bf16_f32 v82, v84, v85
    v_cvt_pk_bf16_f32 v83, v86, v87
    s_nop 1
    v_mfma_f32_32x32x16_bf16 v[192:207], a[16:19], v[80:83], v[192:207]
    v_fma_f32 v88, v88, s20, -v4
    v_fma_f32 v89, v89, s20, -v4
    v_fma_f32 v90, v90, s20, -v4
    v_fma_f32 v91, v91, s20, -v4
    v_fma_f32 v92, v92, s20, -v4
    v_fma_f32 v93, v93, s20, -v4
    v_fma_f32 v94, v94, s20, -v4
    v_fma_f32 v95, v95, s20, -v4
    v_exp_f32 v88, v88
    v_exp_f32 v89, v89
    v_exp_f32 v90, v90
    v_exp_f32 v91, v91
    v_exp_f32 v92, v92
    v_exp_f32 v93, v93
    v_exp_f32 v94, v94
    v_exp_f32 v95, v95
    s_nop 0
    v_cvt_pk_bf16_f32 v88, v88, v89
    v_cvt_pk_bf16_f32 v89, v90, v91
    v_cvt_pk_bf16_f32 v90, v92, v93
    v_cvt_pk_bf16_f32 v91, v94, v95
    s_nop 1
    v_mfma_f32_32x32x16_bf16 v[192:207], a[20:23], v[88:91], v[192:207]
    v_fma_f32 v96, v96, s20, -v4
    v_fma_f32 v97, v97, s20, -v4
    v_fma_f32 v98, v98, s20, -v4
    v_fma_f32 v99, v99, s20, -v4
    v_fma_f32 v100, v100, s20, -v4
    v_fma_f32 v101, v101, s20, -v4
    v_fma_f32 v102, v102, s20, -v4
    v_fma_f32 v103, v103, s20, -v4
    v_exp_f32 v96, v96
    v_exp_f32 v97, v97
    v_exp_f32 v98, v98
    v_exp_f32 v99, v99
    v_exp_f32 v100, v100
    v_exp_f32 v101, v101
    v_exp_f32 v102, v102
    v_exp_f32 v103, v103
    s_nop 0
    v_cvt_pk_bf16_f32 v96, v96, v97
    v_cvt_pk_bf16_f32 v97, v98, v99
    v_cvt_pk_bf16_f32 v98, v100, v101
    v_cvt_pk_bf16_f32 v99, v102, v103
    s_nop 1
    v_mfma_f32_32x32x16_bf16 v[192:207], a[24:27], v[96:99], v[192:207]
    v_fma_f32 v104, v104, s20, -v4
    v_fma_f32 v105, v105, s20, -v4
    v_fma_f32 v106, v106, s20, -v4
    v_fma_f32 v107, v107, s20, -v4
    v_fma_f32 v108, v108, s20, -v4
    v_fma_f32 v109, v109, s20, -v4
    v_fma_f32 v110, v110, s20, -v4
    v_fma_f32 v111, v111, s20, -v4
    v_exp_f32 v104, v104
    v_exp_f32 v105, v105
    v_exp_f32 v106, v106
    v_exp_f32 v107, v107
    v_exp_f32 v108, v108
    v_exp_f32 v109, v109
    v_exp_f32 v110, v110
    v_exp_f32 v111, v111
    s_nop 0
    v_cvt_pk_bf16_f32 v104, v104, v105
    v_cvt_pk_bf16_f32 v105, v106, v107
    v_cvt_pk_bf16_f32 v106, v108, v109
    v_cvt_pk_bf16_f32 v107, v110, v111
    s_nop 1
    v_mfma_f32_32x32x16_bf16 v[192:207], a[28:31], v[104:107], v[192:207]
    v_fma_f32 v112, v112, s20, -v4
    v_fma_f32 v113, v113, s20, -v4
    v_fma_f32 v114, v114, s20, -v4
    v_fma_f32 v115, v115, s20, -v4
    v_fma_f32 v116, v116, s20, -v4
    v_fma_f32 v117, v117, s20, -v4
    v_fma_f32 v118, v118, s20, -v4
    v_fma_f32 v119, v119, s20, -v4
    v_exp_f32 v112, v112
    v_exp_f32 v113, v113
    v_exp_f32 v114, v114
    v_exp_f32 v115, v115
    v_exp_f32 v116, v116
    v_exp_f32 v117, v117
    v_exp_f32 v118, v118
    v_exp_f32 v119, v119
    s_nop 0
    v_cvt_pk_bf16_f32 v112, v112, v113
    v_cvt_pk_bf16_f32 v113, v114, v115
    v_cvt_pk_bf16_f32 v114, v116, v117
    v_cvt_pk_bf16_f32 v115, v118, v119
    s_nop 1
    v_mfma_f32_32x32x16_bf16 v[192:207], a[32:35], v[112:115], v[192:207]
    s_waitcnt vmcnt(0)
    v_fma_f32 v120, v120, s20, -v4
    v_fma_f32 v121, v121, s20, -v4
    v_fma_f32 v122, v122, s20, -v4
    v_fma_f32 v123, v123, s20, -v4
    v_fma_f32 v124, v124, s20, -v4
    v_fma_f32 v125, v125, s20, -v4
    v_fma_f32 v126, v126, s20, -v4
    v_fma_f32 v127, v127, s20, -v4
    v_exp_f32 v120, v120
    v_exp_f32 v121, v121
    v_exp_f32 v122, v122
    v_exp_f32 v123, v123
    v_exp_f32 v124, v124
    v_exp_f32 v125, v125
    v_exp_f32 v126, v126
    v_exp_f32 v127, v127
    s_nop 0
    v_cvt_pk_bf16_f32 v120, v120, v121
    v_cvt_pk_bf16_f32 v121, v122, v123
    v_cvt_pk_bf16_f32 v122, v124, v125
    v_cvt_pk_bf16_f32 v123, v126, v127
    s_nop 1
    v_mfma_f32_32x32x16_bf16 v[192:207], v[12:15], v[120:123], v[192:207]
    v_fma_f32 v128, v128, s20, -v4
    v_fma_f32 v129, v129, s20, -v4
    v_fma_f32 v130, v130, s20, -v4
    v_fma_f32 v131, v131, s20, -v4
    v_fma_f32 v132, v132, s20, -v4
    v_fma_f32 v133, v133, s20, -v4
    v_fma_f32 v134, v134, s20, -v4
    v_fma_f32 v135, v135, s20, -v4
    v_exp_f32 v128, v128
    v_exp_f32 v129, v129
    v_exp_f32 v130, v130
    v_exp_f32 v131, v131
    v_exp_f32 v132, v132
    v_exp_f32 v133, v133
    v_exp_f32 v134, v134
    v_exp_f32 v135, v135
    s_nop 0
    v_cvt_pk_bf16_f32 v128, v128, v129
    v_cvt_pk_bf16_f32 v129, v130, v131
    v_cvt_pk_bf16_f32 v130, v132, v133
    v_cvt_pk_bf16_f32 v131, v134, v135
    s_nop 1
    v_mfma_f32_32x32x16_bf16 v[192:207], v[16:19], v[128:131], v[192:207]
    v_fma_f32 v136, v136, s20, -v4
    v_fma_f32 v137, v137, s20, -v4
    v_fma_f32 v138, v138, s20, -v4
    v_fma_f32 v139, v139, s20, -v4
    v_fma_f32 v140, v140, s20, -v4
    v_fma_f32 v141, v141, s20, -v4
    v_fma_f32 v142, v142, s20, -v4
    v_fma_f32 v143, v143, s20, -v4
    v_exp_f32 v136, v136
    v_exp_f32 v137, v137
    v_exp_f32 v138, v138
    v_exp_f32 v139, v139
    v_exp_f32 v140, v140
    v_exp_f32 v141, v141
    v_exp_f32 v142, v142
    v_exp_f32 v143, v143
    s_nop 0
    v_cvt_pk_bf16_f32 v136, v136, v137
    v_cvt_pk_bf16_f32 v137, v138, v139
    v_cvt_pk_bf16_f32 v138, v140, v141
    v_cvt_pk_bf16_f32 v139, v142, v143
    s_nop 1
    v_mfma_f32_32x32x16_bf16 v[192:207], v[20:23], v[136:139], v[192:207]
    v_fma_f32 v144, v144, s20, -v4
    v_fma_f32 v145, v145, s20, -v4
    v_fma_f32 v146, v146, s20, -v4
    v_fma_f32 v147, v147, s20, -v4
    v_fma_f32 v148, v148, s20, -v4
    v_fma_f32 v149, v149, s20, -v4
    v_fma_f32 v150, v150, s20, -v4
    v_fma_f32 v151, v151, s20, -v4
    v_exp_f32 v144, v144
    v_exp_f32 v145, v145
    v_exp_f32 v146, v146
    v_exp_f32 v147, v147
    v_exp_f32 v148, v148
    v_exp_f32 v149, v149
    v_exp_f32 v150, v150
    v_exp_f32 v151, v151
    s_nop 0
    v_cvt_pk_bf16_f32 v144, v144, v145
    v_cvt_pk_bf16_f32 v145, v146, v147
    v_cvt_pk_bf16_f32 v146, v148, v149
    v_cvt_pk_bf16_f32 v147, v150, v151
    s_nop 1
    v_mfma_f32_32x32x16_bf16 v[192:207], v[24:27], v[144:147], v[192:207]
    v_fma_f32 v152, v152, s20, -v4
    v_fma_f32 v153, v153, s20, -v4
    v_fma_f32 v154, v154, s20, -v4
    v_fma_f32 v155, v155, s20, -v4
    v_fma_f32 v156, v156, s20, -v4
    v_fma_f32 v157, v157, s20, -v4
    v_fma_f32 v158, v158, s20, -v4
    v_fma_f32 v159, v159, s20, -v4
    v_exp_f32 v152, v152
    v_exp_f32 v153, v153
    v_exp_f32 v154, v154
    v_exp_f32 v155, v155
    v_exp_f32 v156, v156
    v_exp_f32 v157, v157
    v_exp_f32 v158, v158
    v_exp_f32 v159, v159
    s_nop 0
    v_cvt_pk_bf16_f32 v152, v152, v153
    v_cvt_pk_bf16_f32 v153, v154, v155
    v_cvt_pk_bf16_f32 v154, v156, v157
    v_cvt_pk_bf16_f32 v155, v158, v159
    s_nop 1
    v_mfma_f32_32x32x16_bf16 v[192:207], v[28:31], v[152:155], v[192:207]
    v_fma_f32 v160, v160, s20, -v4
    v_fma_f32 v161, v161, s20, -v4
    v_fma_f32 v162, v162, s20, -v4
    v_fma_f32 v163, v163, s20, -v4
    v_fma_f32 v164, v164, s20, -v4
    v_fma_f32 v165, v165, s20, -v4
    v_fma_f32 v166, v166, s20, -v4
    v_fma_f32 v167, v167, s20, -v4
    v_exp_f32 v160, v160
    v_exp_f32 v161, v161
    v_exp_f32 v162, v162
    v_exp_f32 v163, v163
    v_exp_f32 v164, v164
    v_exp_f32 v165, v165
    v_exp_f32 v166, v166
    v_exp_f32 v167, v167
    s_nop 0
    v_cvt_pk_bf16_f32 v160, v160, v161
    v_cvt_pk_bf16_f32 v161, v162, v163
    v_cvt_pk_bf16_f32 v162, v164, v165
    v_cvt_pk_bf16_f32 v163, v166, v167
    s_nop 1
    v_mfma_f32_32x32x16_bf16 v[192:207], v[32:35], v[160:163], v[192:207]
    v_fma_f32 v168, v168, s20, -v4
    v_fma_f32 v169, v169, s20, -v4
    v_fma_f32 v170, v170, s20, -v4
    v_fma_f32 v171, v171, s20, -v4
    v_fma_f32 v172, v172, s20, -v4
    v_fma_f32 v173, v173, s20, -v4
    v_fma_f32 v174, v174, s20, -v4
    v_fma_f32 v175, v175, s20, -v4
    v_exp_f32 v168, v168
    v_exp_f32 v169, v169
    v_exp_f32 v170, v170
    v_exp_f32 v171, v171
    v_exp_f32 v172, v172
    v_exp_f32 v173, v173
    v_exp_f32 v174, v174
    v_exp_f32 v175, v175
    s_nop 0
    v_cvt_pk_bf16_f32 v168, v168, v169
    v_cvt_pk_bf16_f32 v169, v170, v171
    v_cvt_pk_bf16_f32 v170, v172, v173
    v_cvt_pk_bf16_f32 v171, v174, v175
    s_nop 1
    v_mfma_f32_32x32x16_bf16 v[192:207], v[36:39], v[168:171], v[192:207]
    v_fma_f32 v176, v176, s20, -v4
    v_fma_f32 v177, v177, s20, -v4
    v_fma_f32 v178, v178, s20, -v4
    v_fma_f32 v179, v179, s20, -v4
    v_fma_f32 v180, v180, s20, -v4
    v_fma_f32 v181, v181, s20, -v4
    v_fma_f32 v182, v182, s20, -v4
    v_fma_f32 v183, v183, s20, -v4
    v_exp_f32 v176, v176
    v_exp_f32 v177, v177
    v_exp_f32 v178, v178
    v_exp_f32 v179, v179
    v_exp_f32 v180, v180
    v_exp_f32 v181, v181
    v_exp_f32 v182, v182
    v_exp_f32 v183, v183
    s_nop 0
    v_cvt_pk_bf16_f32 v176, v176, v177
    v_cvt_pk_bf16_f32 v177, v178, v179
    v_cvt_pk_bf16_f32 v178, v180, v181
    v_cvt_pk_bf16_f32 v179, v182, v183
    s_nop 1
    v_mfma_f32_32x32x16_bf16 v[192:207], v[40:43], v[176:179], v[192:207]
    v_fma_f32 v184, v184, s20, -v4
    v_fma_f32 v185, v185, s20, -v4
    v_fma_f32 v186, v186, s20, -v4
    v_fma_f32 v187, v187, s20, -v4
    v_fma_f32 v188, v188, s20, -v4
    v_fma_f32 v189, v189, s20, -v4
    v_fma_f32 v190, v190, s20, -v4
    v_fma_f32 v191, v191, s20, -v4
    v_exp_f32 v184, v184
    v_exp_f32 v185, v185
    v_exp_f32 v186, v186
    v_exp_f32 v187, v187
    v_exp_f32 v188, v188
    v_exp_f32 v189, v189
    v_exp_f32 v190, v190
    v_exp_f32 v191, v191
    s_nop 0
    v_cvt_pk_bf16_f32 v184, v184, v185
    v_cvt_pk_bf16_f32 v185, v186, v187
    v_cvt_pk_bf16_f32 v186, v188, v189
    v_cvt_pk_bf16_f32 v187, v190, v191
    s_nop 1
    v_mfma_f32_32x32x16_bf16 v[192:207], v[44:47], v[184:187], v[192:207]
    s_nop 7
    s_nop 7
    v_rcp_f32 v4, v200
    s_nop 0
    v_mul_f32 v192, v192, v4
    v_mul_f32 v193, v193, v4
    v_mul_f32 v194, v194, v4
    v_mul_f32 v195, v195, v4
    v_mul_f32 v196, v196, v4
    v_mul_f32 v197, v197, v4
    v_mul_f32 v198, v198, v4
    v_mul_f32 v199, v199, v4
    v_cvt_pk_bf16_f32 v8, v192, v193
    v_cvt_pk_bf16_f32 v9, v194, v195
    v_cvt_pk_bf16_f32 v10, v196, v197
    v_cvt_pk_bf16_f32 v11, v198, v199
    v_lshrrev_b32 v5, 4, v2
    v_lshlrev_b32 v5, 14, v5
    v_and_b32 v6, 15, v2
    v_lshl_add_u32 v5, v6, 4, v5
    v_lshl_add_u32 v5, v3, 3, v5
    s_lshl_b32 s19, s6, 9
    s_lshl_b32 s21, s5, 10
    s_add_u32 s19, s19, s21
    s_add_u32 s19, s19, 23068672
    buffer_store_dwordx2 v[8:9], v5, s[8:11], s19 offen
    buffer_store_dwordx2 v[10:11], v5, s[8:11], s19 offen offset:256
L_end_attn_kernel:
    s_endpgm
.section .rodata,"a"
.p2align 6
.amdhsa_kernel attn_kernel
  .amdhsa_next_free_vgpr 244
  .amdhsa_next_free_sgpr 96
  .amdhsa_accum_offset 208
  .amdhsa_group_segment_fixed_size 0
  .amdhsa_kernarg_size 120
  .amdhsa_user_sgpr_count 2
  .amdhsa_user_sgpr_kernarg_segment_ptr 1
  .amdhsa_system_sgpr_workgroup_id_x 1
.end_amdhsa_kernel
.text

.globl oproj1_kernel
.p2align 8
.type oproj1_kernel,@function
oproj1_kernel:
    s_cmp_ge_u32 s2, 256
    s_cbranch_scc1 L_end_oproj1_kernel
    s_load_dwordx2 s[8:9], s[0:1], 112
    s_mov_b32 s10, 25165824
    s_mov_b32 s11, 0x00020000
    v_lshrrev_b32 v1, 6, v0
    v_and_b32 v2, 63, v0
    v_and_b32 v3, 15, v2
    v_lshrrev_b32 v4, 4, v2
    s_nop 0
    v_readfirstlane_b32 s4, v1
    s_and_b32 s5, s2, 7
    s_lshl_b32 s5, s5, 3
    s_bfe_u32 s6, s2, 0x30003
    s_add_u32 s5, s5, s6
    s_lshl_b32 s5, s5, 5
    s_lshr_b32 s22, s2, 6
    s_lshl_b32 s7, s22, 7
    s_lshl_b32 s6, s4, 5
    s_add_u32 s7, s7, s6
    s_lshl_b32 s16, s7, 10
    s_add_u32 s16, s16, 15728640
    s_lshl_b32 s17, s5, 10
    s_add_u32 s17, s17, 23068672
    s_add_u32 s18, s16, 16384
    s_add_u32 s19, s17, 16384
    s_waitcnt lgkmcnt(0)
    v_lshlrev_b32 v5, 4, v2
    v_lshl_add_u32 v6, v1, 12, v5
    buffer_load_dwordx4 v[16:19], v6, s[8:11], s17 offen offset:0
    buffer_load_dwordx4 v[20:23], v6, s[8:11], s17 offen offset:1024
    buffer_load_dwordx4 v[24:27], v6, s[8:11], s17 offen offset:2048
    buffer_load_dwordx4 v[28:31], v6, s[8:11], s17 offen offset:3072
    buffer_load_dwordx4 v[32:35], v6, s[8:11], s19 offen offset:0
    buffer_load_dwordx4 v[36:39], v6, s[8:11], s19 offen offset:1024
    buffer_load_dwordx4 v[40:43], v6, s[8:11], s19 offen offset:2048
    buffer_load_dwordx4 v[44:47], v6, s[8:11], s19 offen offset:3072
    v_lshlrev_b32 v8, 14, v4
    v_lshl_add_u32 v8, v3, 1, v8
    s_lshl_b32 s20, s7, 12
    s_lshl_b32 s21, s5, 1
    s_add_u32 s20, s20, s21
    s_add_u32 s21, s20, 4194304
    s_add_u32 s20, s20, 2097152
    v_lshlrev_b32 v7, 12, v3
    v_lshl_add_u32 v7, v4, 3, v7
    s_add_u32 s23, s20, 65536
    s_add_u32 s24, s21, 65536
    v_lshlrev_b32 v9, 4, v2
    buffer_load_dwordx4 a[0:3], v5, s[8:11], s16 offen offset:0
    buffer_load_dwordx4 a[64:67], v5, s[8:11], s18 offen offset:0
    buffer_load_dwordx4 a[4:7], v5, s[8:11], s16 offen offset:1024
    buffer_load_dwordx4 a[68:71], v5, s[8:11], s18 offen offset:1024
    buffer_load_dwordx4 a[8:11], v5, s[8:11], s16 offen offset:2048
    buffer_load_dwordx4 a[72:75], v5, s[8:11], s18 offen offset:2048
    buffer_load_dwordx4 a[12:15], v5, s[8:11], s16 offen offset:3072
    buffer_load_dwordx4 a[76:79], v5, s[8:11], s18 offen offset:3072
    v_add_u32 v5, 4096, v5
    buffer_load_dwordx4 a[16:19], v5, s[8:11], s16 offen offset:0
    buffer_load_dwordx4 a[80:83], v5, s[8:11], s18 offen offset:0
    buffer_load_dwordx4 a[20:23], v5, s[8:11], s16 offen offset:1024
    buffer_load_dwordx4 a[84:87], v5, s[8:11], s18 offen offset:1024
    buffer_load_dwordx4 a[24:27], v5, s[8:11], s16 offen offset:2048
    buffer_load_dwordx4 a[88:91], v5, s[8:11], s18 offen offset:2048
    buffer_load_dwordx4 a[28:31], v5, s[8:11], s16 offen offset:3072
    buffer_load_dwordx4 a[92:95], v5, s[8:11], s18 offen offset:3072
    v_add_u32 v5, 4096, v5
    s_waitcnt vmcnt(16)
    ds_write_b128 v6, v[16:19] offset:0
    ds_write_b128 v6, v[20:23] offset:1024
    ds_write_b128 v6, v[24:27] offset:2048
    ds_write_b128 v6, v[28:31] offset:3072
    ds_write_b128 v6, v[32:35] offset:16384
    ds_write_b128 v6, v[36:39] offset:17408
    ds_write_b128 v6, v[40:43] offset:18432
    ds_write_b128 v6, v[44:47] offset:19456
    s_waitcnt lgkmcnt(0)
    s_barrier
    ds_read_b128 v[16:19], v9 offset:0
    ds_read_b128 v[80:83], v9 offset:16384
    ds_read_b128 v[20:23], v9 offset:1024
    ds_read_b128 v[84:87], v9 offset:17408
    ds_read_b128 v[24:27], v9 offset:2048
    ds_read_b128 v[88:91], v9 offset:18432
    buffer_load_dwordx4 a[32:35], v5, s[8:11], s16 offen offset:0
    buffer_load_dwordx4 a[96:99], v5, s[8:11], s18 offen offset:0
    ds_read_b128 v[28:31], v9 offset:3072
    ds_read_b128 v[92:95], v9 offset:19456
    s_waitcnt vmcnt(16) lgkmcnt(6)
    v_mfma_f32_16x16x32_bf16 v[160:163], v[16:19], a[0:3], 0
    v_mfma_f32_16x16x32_bf16 v[164:167], v[80:83], a[0:3], 0
    v_mfma_f32_16x16x32_bf16 v[168:171], v[16:19], a[64:67], 0
    v_mfma_f32_16x16x32_bf16 v[172:175], v[80:83], a[64:67], 0
    buffer_load_dwordx4 a[36:39], v5, s[8:11], s16 offen offset:1024
    buffer_load_dwordx4 a[100:103], v5, s[8:11], s18 offen offset:1024
    ds_read_b128 v[32:35], v9 offset:4096
    ds_read_b128 v[96:99], v9 offset:20480
    s_waitcnt vmcnt(16) lgkmcnt(6)
    v_mfma_f32_16x16x32_bf16 v[160:163], v[20:23], a[4:7], v[160:163]
    v_mfma_f32_16x16x32_bf16 v[164:167], v[84:87], a[4:7], v[164:167]
    v_mfma_f32_16x16x32_bf16 v[168:171], v[20:23], a[68:71], v[168:171]
    v_mfma_f32_16x16x32_bf16 v[172:175], v[84:87], a[68:71], v[172:175]
    buffer_load_dwordx4 a[40:43], v5, s[8:11], s16 offen offset:2048
    buffer_load_dwordx4 a[104:107], v5, s[8:11], s18 offen offset:2048
    ds_read_b128 v[36:39], v9 offset:5120
    ds_read_b128 v[100:103], v9 offset:21504
    s_waitcnt vmcnt(16) lgkmcnt(6)
    v_mfma_f32_16x16x32_bf16 v[160:163], v[24:27], a[8:11], v[160:163]
    v_mfma_f32_16x16x32_bf16 v[164:167], v[88:91], a[8:11], v[164:167]
    v_mfma_f32_16x16x32_bf16 v[168:171], v[24:27], a[72:75], v[168:171]
    v_mfma_f32_16x16x32_bf16 v[172:175], v[88:91], a[72:75], v[172:175]
    buffer_load_dwordx4 a[44:47], v5, s[8:11], s16 offen offset:3072
    buffer_load_dwordx4 a[108:111], v5, s[8:11], s18 offen offset:3072
    v_add_u32 v5, 4096, v5
    ds_read_b128 v[40:43], v9 offset:6144
    ds_read_b128 v[104:107], v9 offset:22528
    s_waitcnt vmcnt(16) lgkmcnt(6)
    v_mfma_f32_16x16x32_bf16 v[160:163], v[28:31], a[12:15], v[160:163]
    v_mfma_f32_16x16x32_bf16 v[164:167], v[92:95], a[12:15], v[164:167]
    v_mfma_f32_16x16x32_bf16 v[168:171], v[28:31], a[76:79], v[168:171]
    v_mfma_f32_16x16x32_bf16 v[172:175], v[92:95], a[76:79], v[172:175]
    buffer_load_dwordx4 a[48:51], v5, s[8:11], s16 offen offset:0
    buffer_load_dwordx4 a[112:115], v5, s[8:11], s18 offen offset:0
    ds_read_b128 v[44:47], v9 offset:7168
    ds_read_b128 v[108:111], v9 offset:23552
    s_waitcnt vmcnt(16) lgkmcnt(6)
    v_mfma_f32_16x16x32_bf16 v[160:163], v[32:35], a[16:19], v[160:163]
    v_mfma_f32_16x16x32_bf16 v[164:167], v[96:99], a[16:19], v[164:167]
    v_mfma_f32_16x16x32_bf16 v[168:171], v[32:35], a[80:83], v[168:171]
    v_mfma_f32_16x16x32_bf16 v[172:175], v[96:99], a[80:83], v[172:175]
    buffer_load_dwordx4 a[52:55], v5, s[8:11], s16 offen offset:1024
    buffer_load_dwordx4 a[116:119], v5, s[8:11], s18 offen offset:1024
    ds_read_b128 v[48:51], v9 offset:8192
    ds_read_b128 v[112:115], v9 offset:24576
    s_waitcnt vmcnt(16) lgkmcnt(6)
    v_mfma_f32_16x16x32_bf16 v[160:163], v[36:39], a[20:23], v[160:163]
    v_mfma_f32_16x16x32_bf16 v[164:167], v[100:103], a[20:23], v[164:167]
    v_mfma_f32_16x16x32_bf16 v[168:171], v[36:39], a[84:87], v[168:171]
    v_mfma_f32_16x16x32_bf16 v[172:175], v[100:103], a[84:87], v[172:175]
    buffer_load_dwordx4 a[56:59], v5, s[8:11], s16 offen offset:2048
    buffer_load_dwordx4 a[120:123], v5, s[8:11], s18 offen offset:2048
    ds_read_b128 v[52:55], v9 offset:9216
    ds_read_b128 v[116:119], v9 offset:25600
    s_waitcnt vmcnt(16) lgkmcnt(6)
    v_mfma_f32_16x16x32_bf16 v[160:163], v[40:43], a[24:27], v[160:163]
    v_mfma_f32_16x16x32_bf16 v[164:167], v[104:107], a[24:27], v[164:167]
    v_mfma_f32_16x16x32_bf16 v[168:171], v[40:43], a[88:91], v[168:171]
    v_mfma_f32_16x16x32_bf16 v[172:175], v[104:107], a[88:91], v[172:175]
    buffer_load_dwordx4 a[60:63], v5, s[8:11], s16 offen offset:3072
    buffer_load_dwordx4 a[124:127], v5, s[8:11], s18 offen offset:3072
    v_add_u32 v5, 4096, v5
    buffer_load_dwordx2 v[144:145], v7, s[8:11], s20 offen offset:0
    buffer_load_dwordx2 v[146:147], v7, s[8:11], s20 offen offset:32
    buffer_load_dwordx2 v[148:149], v7, s[8:11], s23 offen offset:0
    buffer_load_dwordx2 v[150:151], v7, s[8:11], s23 offen offset:32
    ds_read_b128 v[56:59], v9 offset:10240
    ds_read_b128 v[120:123], v9 offset:26624
    s_waitcnt vmcnt(20) lgkmcnt(6)
    v_mfma_f32_16x16x32_bf16 v[160:163], v[44:47], a[28:31], v[160:163]
    v_mfma_f32_16x16x32_bf16 v[164:167], v[108:111], a[28:31], v[164:167]
    v_mfma_f32_16x16x32_bf16 v[168:171], v[44:47], a[92:95], v[168:171]
    v_mfma_f32_16x16x32_bf16 v[172:175], v[108:111], a[92:95], v[172:175]
    ds_read_b128 v[60:63], v9 offset:11264
    ds_read_b128 v[124:127], v9 offset:27648
    s_waitcnt vmcnt(18) lgkmcnt(6)
    v_mfma_f32_16x16x32_bf16 v[160:163], v[48:51], a[32:35], v[160:163]
    v_mfma_f32_16x16x32_bf16 v[164:167], v[112:115], a[32:35], v[164:167]
    v_mfma_f32_16x16x32_bf16 v[168:171], v[48:51], a[96:99], v[168:171]
    v_mfma_f32_16x16x32_bf16 v[172:175], v[112:115], a[96:99], v[172:175]
    ds_read_b128 v[64:67], v9 offset:12288
    ds_read_b128 v[128:131], v9 offset:28672
    s_waitcnt vmcnt(16) lgkmcnt(6)
    v_mfma_f32_16x16x32_bf16 v[160:163], v[52:55], a[36:39], v[160:163]
    v_mfma_f32_16x16x32_bf16 v[164:167], v[116:119], a[36:39], v[164:167]
    v_mfma_f32_16x16x32_bf16 v[168:171], v[52:55], a[100:103], v[168:171]
    v_mfma_f32_16x16x32_bf16 v[172:175], v[116:119], a[100:103], v[172:175]
    ds_read_b128 v[68:71], v9 offset:13312
    ds_read_b128 v[132:135], v9 offset:29696
    s_waitcnt vmcnt(14) lgkmcnt(6)
    v_mfma_f32_16x16x32_bf16 v[160:163], v[56:59], a[40:43], v[160:163]
    v_mfma_f32_16x16x32_bf16 v[164:167], v[120:123], a[40:43], v[164:167]
    v_mfma_f32_16x16x32_bf16 v[168:171], v[56:59], a[104:107], v[168:171]
    v_mfma_f32_16x16x32_bf16 v[172:175], v[120:123], a[104:107], v[172:175]
    ds_read_b128 v[72:75], v9 offset:14336
    ds_read_b128 v[136:139], v9 offset:30720
    s_waitcnt vmcnt(12) lgkmcnt(6)
    v_mfma_f32_16x16x32_bf16 v[160:163], v[60:63], a[44:47], v[160:163]
    v_mfma_f32_16x16x32_bf16 v[164:167], v[124:127], a[44:47], v[164:167]
    v_mfma_f32_16x16x32_bf16 v[168:171], v[60:63], a[108:111], v[168:171]
    v_mfma_f32_16x16x32_bf16 v[172:175], v[124:127], a[108:111], v[172:175]
    ds_read_b128 v[76:79], v9 offset:15360
    ds_read_b128 v[140:143], v9 offset:31744
    s_waitcnt vmcnt(10) lgkmcnt(6)
    v_mfma_f32_16x16x32_bf16 v[160:163], v[64:67], a[48:51], v[160:163]
    v_mfma_f32_16x16x32_bf16 v[164:167], v[128:131], a[48:51], v[164:167]
    v_mfma_f32_16x16x32_bf16 v[168:171], v[64:67], a[112:115], v[168:171]
    v_mfma_f32_16x16x32_bf16 v[172:175], v[128:131], a[112:115], v[172:175]
    s_waitcnt vmcnt(8) lgkmcnt(4)
    v_mfma_f32_16x16x32_bf16 v[160:163], v[68:71], a[52:55], v[160:163]
    v_mfma_f32_16x16x32_bf16 v[164:167], v[132:135], a[52:55], v[164:167]
    v_mfma_f32_16x16x32_bf16 v[168:171], v[68:71], a[116:119], v[168:171]
    v_mfma_f32_16x16x32_bf16 v[172:175], v[132:135], a[116:119], v[172:175]
    s_waitcnt vmcnt(6) lgkmcnt(2)
    v_mfma_f32_16x16x32_bf16 v[160:163], v[72:75], a[56:59], v[160:163]
    v_mfma_f32_16x16x32_bf16 v[164:167], v[136:139], a[56:59], v[164:167]
    v_mfma_f32_16x16x32_bf16 v[168:171], v[72:75], a[120:123], v[168:171]
    v_mfma_f32_16x16x32_bf16 v[172:175], v[136:139], a[120:123], v[172:175]
    s_waitcnt vmcnt(4) lgkmcnt(0)
    v_mfma_f32_16x16x32_bf16 v[160:163], v[76:79], a[60:63], v[160:163]
    v_mfma_f32_16x16x32_bf16 v[164:167], v[140:143], a[60:63], v[164:167]
    v_mfma_f32_16x16x32_bf16 v[168:171], v[76:79], a[124:127], v[168:171]
    v_mfma_f32_16x16x32_bf16 v[172:175], v[140:143], a[124:127], v[172:175]
    v_add_u32 v8, s5, v3
    v_lshlrev_b32 v8, 10, v8
    v_lshl_add_u32 v8, v4, 3, v8
    v_add_u32 v9, 16384, v8
    s_lshl_b32 s16, s7, 1
    s_nop 7
    s_waitcnt vmcnt(0)
    v_cvt_pk_bf16_f32 v160, v160, v160
    v_lshlrev_b32 v160, 16, v160
    v_lshlrev_b32 v10, 16, v144
    v_add_f32 v160, v160, v10
    v_cvt_pk_bf16_f32 v161, v161, v161
    v_lshlrev_b32 v161, 16, v161
    v_and_b32 v11, 0xffff0000, v144
    v_add_f32 v161, v161, v11
    v_cvt_pk_bf16_f32 v162, v162, v162
    v_lshlrev_b32 v162, 16, v162
    v_lshlrev_b32 v10, 16, v145
    v_add_f32 v162, v162, v10
    v_cvt_pk_bf16_f32 v163, v163, v163
    v_lshlrev_b32 v163, 16, v163
    v_and_b32 v11, 0xffff0000, v145
    v_add_f32 v163, v163, v11
    v_cvt_pk_bf16_f32 v164, v164, v164
    v_lshlrev_b32 v164, 16, v164
    v_lshlrev_b32 v10, 16, v146
    v_add_f32 v164, v164, v10
    v_cvt_pk_bf16_f32 v165, v165, v165
    v_lshlrev_b32 v165, 16, v165
    v_and_b32 v11, 0xffff0000, v146
    v_add_f32 v165, v165, v11
    v_cvt_pk_bf16_f32 v166, v166, v166
    v_lshlrev_b32 v166, 16, v166
    v_lshlrev_b32 v10, 16, v147
    v_add_f32 v166, v166, v10
    v_cvt_pk_bf16_f32 v167, v167, v167
    v_lshlrev_b32 v167, 16, v167
    v_and_b32 v11, 0xffff0000, v147
    v_add_f32 v167, v167, v11
    v_cvt_pk_bf16_f32 v168, v168, v168
    v_lshlrev_b32 v168, 16, v168
    v_lshlrev_b32 v10, 16, v148
    v_add_f32 v168, v168, v10
    v_cvt_pk_bf16_f32 v169, v169, v169
    v_lshlrev_b32 v169, 16, v169
    v_and_b32 v11, 0xffff0000, v148
    v_add_f32 v169, v169, v11
    v_cvt_pk_bf16_f32 v170, v170, v170
    v_lshlrev_b32 v170, 16, v170
    v_lshlrev_b32 v10, 16, v149
    v_add_f32 v170, v170, v10
    v_cvt_pk_bf16_f32 v171, v171, v171
    v_lshlrev_b32 v171, 16, v171
    v_and_b32 v11, 0xffff0000, v149
    v_add_f32 v171, v171, v11
    v_cvt_pk_bf16_f32 v172, v172, v172
    v_lshlrev_b32 v172, 16, v172
    v_lshlrev_b32 v10, 16, v150
    v_add_f32 v172, v172, v10
    v_cvt_pk_bf16_f32 v173, v173, v173
    v_lshlrev_b32 v173, 16, v173
    v_and_b32 v11, 0xffff0000, v150
    v_add_f32 v173, v173, v11
    v_cvt_pk_bf16_f32 v174, v174, v174
    v_lshlrev_b32 v174, 16, v174
    v_lshlrev_b32 v10, 16, v151
    v_add_f32 v174, v174, v10
    v_cvt_pk_bf16_f32 v175, v175, v175
    v_lshlrev_b32 v175, 16, v175
    v_and_b32 v11, 0xffff0000, v151
    v_add_f32 v175, v175, v11
    v_cvt_pk_bf16_f32 v144, v160, v161
    v_cvt_pk_bf16_f32 v145, v162, v163
    buffer_store_dwordx2 v[144:145], v7, s[8:11], s21 offen offset:0
    v_lshlrev_b32 v16, 16, v144
    v_mul_f32 v17, v16, v16
    v_and_b32 v18, 0xffff0000, v144
    v_mul_f32 v19, v18, v18
    v_lshlrev_b32 v20, 16, v145
    v_mul_f32 v21, v20, v20
    v_and_b32 v22, 0xffff0000, v145
    v_mul_f32 v23, v22, v22
    v_cvt_pk_bf16_f32 v146, v164, v165
    v_cvt_pk_bf16_f32 v147, v166, v167
    buffer_store_dwordx2 v[146:147], v7, s[8:11], s21 offen offset:32
    v_lshlrev_b32 v24, 16, v146
    v_mul_f32 v25, v24, v24
    v_and_b32 v26, 0xffff0000, v146
    v_mul_f32 v27, v26, v26
    v_lshlrev_b32 v28, 16, v147
    v_mul_f32 v29, v28, v28
    v_and_b32 v30, 0xffff0000, v147
    v_mul_f32 v31, v30, v30
    v_cvt_pk_bf16_f32 v148, v168, v169
    v_cvt_pk_bf16_f32 v149, v170, v171
    buffer_store_dwordx2 v[148:149], v7, s[8:11], s24 offen offset:0
    v_lshlrev_b32 v10, 16, v148
    v_add_f32 v16, v16, v10
    v_fmac_f32 v17, v10, v10
    v_and_b32 v11, 0xffff0000, v148
    v_add_f32 v18, v18, v11
    v_fmac_f32 v19, v11, v11
    v_lshlrev_b32 v10, 16, v149
    v_add_f32 v20, v20, v10
    v_fmac_f32 v21, v10, v10
    v_and_b32 v11, 0xffff0000, v149
    v_add_f32 v22, v22, v11
    v_fmac_f32 v23, v11, v11
    v_cvt_pk_bf16_f32 v150, v172, v173
    v_cvt_pk_bf16_f32 v151, v174, v175
    buffer_store_dwordx2 v[150:151], v7, s[8:11], s24 offen offset:32
    v_lshlrev_b32 v10, 16, v150
    v_add_f32 v24, v24, v10
    v_fmac_f32 v25, v10, v10
    v_and_b32 v11, 0xffff0000, v150
    v_add_f32 v26, v26, v11
    v_fmac_f32 v27, v11, v11
    v_lshlrev_b32 v10, 16, v151
    v_add_f32 v28, v28, v10
    v_fmac_f32 v29, v10, v10
    v_and_b32 v11, 0xffff0000, v151
    v_add_f32 v30, v30, v11
    v_fmac_f32 v31, v11, v11
    s_nop 1
    v_add_f32_dpp v16, v16, v16 row_shr:1 row_mask:0xf bank_mask:0xf bound_ctrl:0
    v_add_f32_dpp v17, v17, v17 row_shr:1 row_mask:0xf bank_mask:0xf bound_ctrl:0
    v_add_f32_dpp v18, v18, v18 row_shr:1 row_mask:0xf bank_mask:0xf bound_ctrl:0
    v_add_f32_dpp v19, v19, v19 row_shr:1 row_mask:0xf bank_mask:0xf bound_ctrl:0
    v_add_f32_dpp v20, v20, v20 row_shr:1 row_mask:0xf bank_mask:0xf bound_ctrl:0
    v_add_f32_dpp v21, v21, v21 row_shr:1 row_mask:0xf bank_mask:0xf bound_ctrl:0
    v_add_f32_dpp v22, v22, v22 row_shr:1 row_mask:0xf bank_mask:0xf bound_ctrl:0
    v_add_f32_dpp v23, v23, v23 row_shr:1 row_mask:0xf bank_mask:0xf bound_ctrl:0
    v_add_f32_dpp v24, v24, v24 row_shr:1 row_mask:0xf bank_mask:0xf bound_ctrl:0
    v_add_f32_dpp v25, v25, v25 row_shr:1 row_mask:0xf bank_mask:0xf bound_ctrl:0
    v_add_f32_dpp v26, v26, v26 row_shr:1 row_mask:0xf bank_mask:0xf bound_ctrl:0
    v_add_f32_dpp v27, v27, v27 row_shr:1 row_mask:0xf bank_mask:0xf bound_ctrl:0
    v_add_f32_dpp v28, v28, v28 row_shr:1 row_mask:0xf bank_mask:0xf bound_ctrl:0
    v_add_f32_dpp v29, v29, v29 row_shr:1 row_mask:0xf bank_mask:0xf bound_ctrl:0
    v_add_f32_dpp v30, v30, v30 row_shr:1 row_mask:0xf bank_mask:0xf bound_ctrl:0
    v_add_f32_dpp v31, v31, v31 row_shr:1 row_mask:0xf bank_mask:0xf bound_ctrl:0
    v_add_f32_dpp v16, v16, v16 row_shr:2 row_mask:0xf bank_mask:0xf bound_ctrl:0
    v_add_f32_dpp v17, v17, v17 row_shr:2 row_mask:0xf bank_mask:0xf bound_ctrl:0
    v_add_f32_dpp v18, v18, v18 row_shr:2 row_mask:0xf bank_mask:0xf bound_ctrl:0
    v_add_f32_dpp v19, v19, v19 row_shr:2 row_mask:0xf bank_mask:0xf bound_ctrl:0
    v_add_f32_dpp v20, v20, v20 row_shr:2 row_mask:0xf bank_mask:0xf bound_ctrl:0
    v_add_f32_dpp v21, v21, v21 row_shr:2 row_mask:0xf bank_mask:0xf bound_ctrl:0
    v_add_f32_dpp v22, v22, v22 row_shr:2 row_mask:0xf bank_mask:0xf bound_ctrl:0
    v_add_f32_dpp v23, v23, v23 row_shr:2 row_mask:0xf bank_mask:0xf bound_ctrl:0
    v_add_f32_dpp v24, v24, v24 row_shr:2 row_mask:0xf bank_mask:0xf bound_ctrl:0
    v_add_f32_dpp v25, v25, v25 row_shr:2 row_mask:0xf bank_mask:0xf bound_ctrl:0
    v_add_f32_dpp v26, v26, v26 row_shr:2 row_mask:0xf bank_mask:0xf bound_ctrl:0
    v_add_f32_dpp v27, v27, v27 row_shr:2 row_mask:0xf bank_mask:0xf bound_ctrl:0
    v_add_f32_dpp v28, v28, v28 row_shr:2 row_mask:0xf bank_mask:0xf bound_ctrl:0
    v_add_f32_dpp v29, v29, v29 row_shr:2 row_mask:0xf bank_mask:0xf bound_ctrl:0
    v_add_f32_dpp v30, v30, v30 row_shr:2 row_mask:0xf bank_mask:0xf bound_ctrl:0
    v_add_f32_dpp v31, v31, v31 row_shr:2 row_mask:0xf bank_mask:0xf bound_ctrl:0
    v_add_f32_dpp v16, v16, v16 row_shr:4 row_mask:0xf bank_mask:0xf bound_ctrl:0
    v_add_f32_dpp v17, v17, v17 row_shr:4 row_mask:0xf bank_mask:0xf bound_ctrl:0
    v_add_f32_dpp v18, v18, v18 row_shr:4 row_mask:0xf bank_mask:0xf bound_ctrl:0
    v_add_f32_dpp v19, v19, v19 row_shr:4 row_mask:0xf bank_mask:0xf bound_ctrl:0
    v_add_f32_dpp v20, v20, v20 row_shr:4 row_mask:0xf bank_mask:0xf bound_ctrl:0
    v_add_f32_dpp v21, v21, v21 row_shr:4 row_mask:0xf bank_mask:0xf bound_ctrl:0
    v_add_f32_dpp v22, v22, v22 row_shr:4 row_mask:0xf bank_mask:0xf bound_ctrl:0
    v_add_f32_dpp v23, v23, v23 row_shr:4 row_mask:0xf bank_mask:0xf bound_ctrl:0
    v_add_f32_dpp v24, v24, v24 row_shr:4 row_mask:0xf bank_mask:0xf bound_ctrl:0
    v_add_f32_dpp v25, v25, v25 row_shr:4 row_mask:0xf bank_mask:0xf bound_ctrl:0
    v_add_f32_dpp v26, v26, v26 row_shr:4 row_mask:0xf bank_mask:0xf bound_ctrl:0
    v_add_f32_dpp v27, v27, v27 row_shr:4 row_mask:0xf bank_mask:0xf bound_ctrl:0
    v_add_f32_dpp v28, v28, v28 row_shr:4 row_mask:0xf bank_mask:0xf bound_ctrl:0
    v_add_f32_dpp v29, v29, v29 row_shr:4 row_mask:0xf bank_mask:0xf bound_ctrl:0
    v_add_f32_dpp v30, v30, v30 row_shr:4 row_mask:0xf bank_mask:0xf bound_ctrl:0
    v_add_f32_dpp v31, v31, v31 row_shr:4 row_mask:0xf bank_mask:0xf bound_ctrl:0
    v_add_f32_dpp v16, v16, v16 row_shr:8 row_mask:0xf bank_mask:0xf bound_ctrl:0
    v_add_f32_dpp v17, v17, v17 row_shr:8 row_mask:0xf bank_mask:0xf bound_ctrl:0
    v_add_f32_dpp v18, v18, v18 row_shr:8 row_mask:0xf bank_mask:0xf bound_ctrl:0
    v_add_f32_dpp v19, v19, v19 row_shr:8 row_mask:0xf bank_mask:0xf bound_ctrl:0
    v_add_f32_dpp v20, v20, v20 row_shr:8 row_mask:0xf bank_mask:0xf bound_ctrl:0
    v_add_f32_dpp v21, v21, v21 row_shr:8 row_mask:0xf bank_mask:0xf bound_ctrl:0
    v_add_f32_dpp v22, v22, v22 row_shr:8 row_mask:0xf bank_mask:0xf bound_ctrl:0
    v_add_f32_dpp v23, v23, v23 row_shr:8 row_mask:0xf bank_mask:0xf bound_ctrl:0
    v_add_f32_dpp v24, v24, v24 row_shr:8 row_mask:0xf bank_mask:0xf bound_ctrl:0
    v_add_f32_dpp v25, v25, v25 row_shr:8 row_mask:0xf bank_mask:0xf bound_ctrl:0
    v_add_f32_dpp v26, v26, v26 row_shr:8 row_mask:0xf bank_mask:0xf bound_ctrl:0
    v_add_f32_dpp v27, v27, v27 row_shr:8 row_mask:0xf bank_mask:0xf bound_ctrl:0
    v_add_f32_dpp v28, v28, v28 row_shr:8 row_mask:0xf bank_mask:0xf bound_ctrl:0
    v_add_f32_dpp v29, v29, v29 row_shr:8 row_mask:0xf bank_mask:0xf bound_ctrl:0
    v_add_f32_dpp v30, v30, v30 row_shr:8 row_mask:0xf bank_mask:0xf bound_ctrl:0
    v_add_f32_dpp v31, v31, v31 row_shr:8 row_mask:0xf bank_mask:0xf bound_ctrl:0
    v_lshlrev_b32 v9, 8, v1
    v_lshl_add_u32 v9, v4, 5, v9
    v_cmp_eq_u32 vcc, 15, v3
    s_and_saveexec_b64 s[30:31], vcc
    ds_write_b128 v9, v[16:19] offset:32768
    ds_write_b128 v9, v[20:23] offset:32784
    ds_write_b128 v9, v[24:27] offset:32896
    ds_write_b128 v9, v[28:31] offset:32912
    s_mov_b64 exec, s[30:31]
    s_waitcnt lgkmcnt(0)
    s_barrier
    s_cmp_lg_u32 s4, 0
    s_cbranch_scc1 L_end_oproj1_kernel
    v_and_b32 v9, 31, v2
    v_lshlrev_b32 v9, 3, v9
    ds_read_b64 v[16:17], v9 offset:32768
    ds_read_b64 v[18:19], v9 offset:33024
    ds_read_b64 v[20:21], v9 offset:33280
    ds_read_b64 v[22:23], v9 offset:33536
    s_waitcnt lgkmcnt(0)
    v_pk_add_f32 v[16:17], v[16:17], v[18:19]
    v_pk_add_f32 v[16:17], v[16:17], v[20:21]
    v_pk_add_f32 v[16:17], v[16:17], v[22:23]
    v_bfe_u32 v12, v2, 1, 2
    v_lshlrev_b32 v12, 12, v12
    v_lshrrev_b32 v13, 3, v2
    v_lshl_add_u32 v12, v13, 4, v12
    v_and_b32 v13, 1, v2
    v_lshl_add_u32 v12, v13, 3, v12
    s_lshl_b32 s16, s22, 14
    s_lshl_b32 s17, s5, 1
    s_add_u32 s16, s16, s17
    s_add_u32 s16, s16, 8454144
    v_cmp_gt_u32 vcc, 32, v2
    s_and_saveexec_b64 s[30:31], vcc
    buffer_store_dwordx2 v[16:17], v12, s[8:11], s16 offen
L_end_oproj1_kernel:
    s_endpgm
.section .rodata,"a"
.p2align 6
.amdhsa_kernel oproj1_kernel
  .amdhsa_next_free_vgpr 304
  .amdhsa_next_free_sgpr 96
  .amdhsa_accum_offset 176
  .amdhsa_group_segment_fixed_size 0
  .amdhsa_kernarg_size 120
  .amdhsa_user_sgpr_count 2
  .amdhsa_user_sgpr_kernarg_segment_ptr 1
  .amdhsa_system_sgpr_workgroup_id_x 1
.end_amdhsa_kernel
.text

.globl oproj2_kernel
.p2align 8
.type oproj2_kernel,@function
oproj2_kernel:
    s_cmp_ge_u32 s2, 256
    s_cbranch_scc1 L_end_oproj2_kernel
    s_load_dwordx2 s[8:9], s[0:1], 112
    s_mov_b32 s10, 25165824
    s_mov_b32 s11, 0x00020000
    s_load_dwordx2 s[12:13], s[0:1], 96
    s_mov_b32 s14, 2097152
    s_mov_b32 s15, 0x00020000
    v_lshrrev_b32 v1, 6, v0
    v_and_b32 v2, 63, v0
    v_and_b32 v3, 15, v2
    v_lshrrev_b32 v4, 4, v2
    s_nop 0
    v_readfirstlane_b32 s4, v1
    s_and_b32 s5, s2, 7
    s_lshl_b32 s5, s5, 3
    s_bfe_u32 s6, s2, 0x30003
    s_add_u32 s5, s5, s6
    s_lshl_b32 s5, s5, 5
    s_lshr_b32 s22, s2, 6
    s_lshl_b32 s7, s22, 7
    s_lshl_b32 s6, s4, 5
    s_add_u32 s7, s7, s6
    s_lshl_b32 s16, s7, 10
    s_add_u32 s16, s16, 15728640
    s_lshl_b32 s17, s5, 10
    s_add_u32 s17, s17, 23068672
    s_add_u32 s18, s16, 16384
    s_add_u32 s19, s17, 16384
    s_waitcnt lgkmcnt(0)
    v_lshlrev_b32 v5, 4, v2
    v_lshl_add_u32 v6, v1, 12, v5
    buffer_load_dwordx4 v[16:19], v6, s[8:11], s17 offen offset:0
    buffer_load_dwordx4 v[20:23], v6, s[8:11], s17 offen offset:1024
    buffer_load_dwordx4 v[24:27], v6, s[8:11], s17 offen offset:2048
    buffer_load_dwordx4 v[28:31], v6, s[8:11], s17 offen offset:3072
    buffer_load_dwordx4 v[32:35], v6, s[8:11], s19 offen offset:0
    buffer_load_dwordx4 v[36:39], v6, s[8:11], s19 offen offset:1024
    buffer_load_dwordx4 v[40:43], v6, s[8:11], s19 offen offset:2048
    buffer_load_dwordx4 v[44:47], v6, s[8:11], s19 offen offset:3072
    v_lshlrev_b32 v8, 14, v4
    v_lshl_add_u32 v8, v3, 1, v8
    s_lshl_b32 s20, s7, 12
    s_lshl_b32 s21, s5, 1
    s_add_u32 s20, s20, s21
    s_add_u32 s21, s20, 0
    s_add_u32 s20, s20, 6291456
    v_lshlrev_b32 v7, 12, v3
    v_lshl_add_u32 v7, v4, 3, v7
    s_add_u32 s23, s20, 65536
    s_add_u32 s24, s21, 65536
    v_lshlrev_b32 v9, 4, v2
    buffer_load_dwordx4 a[0:3], v5, s[8:11], s16 offen offset:0
    buffer_load_dwordx4 a[64:67], v5, s[8:11], s18 offen offset:0
    buffer_load_dwordx4 a[4:7], v5, s[8:11], s16 offen offset:1024
    buffer_load_dwordx4 a[68:71], v5, s[8:11], s18 offen offset:1024
    buffer_load_dwordx4 a[8:11], v5, s[8:11], s16 offen offset:2048
    buffer_load_dwordx4 a[72:75], v5, s[8:11], s18 offen offset:2048
    buffer_load_dwordx4 a[12:15], v5, s[8:11], s16 offen offset:3072
    buffer_load_dwordx4 a[76:79], v5, s[8:11], s18 offen offset:3072
    v_add_u32 v5, 4096, v5
    buffer_load_dwordx4 a[16:19], v5, s[8:11], s16 offen offset:0
    buffer_load_dwordx4 a[80:83], v5, s[8:11], s18 offen offset:0
    buffer_load_dwordx4 a[20:23], v5, s[8:11], s16 offen offset:1024
    buffer_load_dwordx4 a[84:87], v5, s[8:11], s18 offen offset:1024
    buffer_load_dwordx4 a[24:27], v5, s[8:11], s16 offen offset:2048
    buffer_load_dwordx4 a[88:91], v5, s[8:11], s18 offen offset:2048
    buffer_load_dwordx4 a[28:31], v5, s[8:11], s16 offen offset:3072
    buffer_load_dwordx4 a[92:95], v5, s[8:11], s18 offen offset:3072
    v_add_u32 v5, 4096, v5
    s_waitcnt vmcnt(16)
    ds_write_b128 v6, v[16:19] offset:0
    ds_write_b128 v6, v[20:23] offset:1024
    ds_write_b128 v6, v[24:27] offset:2048
    ds_write_b128 v6, v[28:31] offset:3072
    ds_write_b128 v6, v[32:35] offset:16384
    ds_write_b128 v6, v[36:39] offset:17408
    ds_write_b128 v6, v[40:43] offset:18432
    ds_write_b128 v6, v[44:47] offset:19456
    s_waitcnt lgkmcnt(0)
    s_barrier
    ds_read_b128 v[16:19], v9 offset:0
    ds_read_b128 v[80:83], v9 offset:16384
    ds_read_b128 v[20:23], v9 offset:1024
    ds_read_b128 v[84:87], v9 offset:17408
    ds_read_b128 v[24:27], v9 offset:2048
    ds_read_b128 v[88:91], v9 offset:18432
    buffer_load_dwordx4 a[32:35], v5, s[8:11], s16 offen offset:0
    buffer_load_dwordx4 a[96:99], v5, s[8:11], s18 offen offset:0
    ds_read_b128 v[28:31], v9 offset:3072
    ds_read_b128 v[92:95], v9 offset:19456
    s_waitcnt vmcnt(16) lgkmcnt(6)
    v_mfma_f32_16x16x32_bf16 v[160:163], a[0:3], v[16:19], 0
    v_mfma_f32_16x16x32_bf16 v[164:167], a[0:3], v[80:83], 0
    v_mfma_f32_16x16x32_bf16 v[168:171], a[64:67], v[16:19], 0
    v_mfma_f32_16x16x32_bf16 v[172:175], a[64:67], v[80:83], 0
    buffer_load_dwordx4 a[36:39], v5, s[8:11], s16 offen offset:1024
    buffer_load_dwordx4 a[100:103], v5, s[8:11], s18 offen offset:1024
    ds_read_b128 v[32:35], v9 offset:4096
    ds_read_b128 v[96:99], v9 offset:20480
    s_waitcnt vmcnt(16) lgkmcnt(6)
    v_mfma_f32_16x16x32_bf16 v[160:163], a[4:7], v[20:23], v[160:163]
    v_mfma_f32_16x16x32_bf16 v[164:167], a[4:7], v[84:87], v[164:167]
    v_mfma_f32_16x16x32_bf16 v[168:171], a[68:71], v[20:23], v[168:171]
    v_mfma_f32_16x16x32_bf16 v[172:175], a[68:71], v[84:87], v[172:175]
    buffer_load_dwordx4 a[40:43], v5, s[8:11], s16 offen offset:2048
    buffer_load_dwordx4 a[104:107], v5, s[8:11], s18 offen offset:2048
    ds_read_b128 v[36:39], v9 offset:5120
    ds_read_b128 v[100:103], v9 offset:21504
    s_waitcnt vmcnt(16) lgkmcnt(6)
    v_mfma_f32_16x16x32_bf16 v[160:163], a[8:11], v[24:27], v[160:163]
    v_mfma_f32_16x16x32_bf16 v[164:167], a[8:11], v[88:91], v[164:167]
    v_mfma_f32_16x16x32_bf16 v[168:171], a[72:75], v[24:27], v[168:171]
    v_mfma_f32_16x16x32_bf16 v[172:175], a[72:75], v[88:91], v[172:175]
    buffer_load_dwordx4 a[44:47], v5, s[8:11], s16 offen offset:3072
    buffer_load_dwordx4 a[108:111], v5, s[8:11], s18 offen offset:3072
    v_add_u32 v5, 4096, v5
    ds_read_b128 v[40:43], v9 offset:6144
    ds_read_b128 v[104:107], v9 offset:22528
    s_waitcnt vmcnt(16) lgkmcnt(6)
    v_mfma_f32_16x16x32_bf16 v[160:163], a[12:15], v[28:31], v[160:163]
    v_mfma_f32_16x16x32_bf16 v[164:167], a[12:15], v[92:95], v[164:167]
    v_mfma_f32_16x16x32_bf16 v[168:171], a[76:79], v[28:31], v[168:171]
    v_mfma_f32_16x16x32_bf16 v[172:175], a[76:79], v[92:95], v[172:175]
    buffer_load_dwordx4 a[48:51], v5, s[8:11], s16 offen offset:0
    buffer_load_dwordx4 a[112:115], v5, s[8:11], s18 offen offset:0
    ds_read_b128 v[44:47], v9 offset:7168
    ds_read_b128 v[108:111], v9 offset:23552
    s_waitcnt vmcnt(16) lgkmcnt(6)
    v_mfma_f32_16x16x32_bf16 v[160:163], a[16:19], v[32:35], v[160:163]
    v_mfma_f32_16x16x32_bf16 v[164:167], a[16:19], v[96:99], v[164:167]
    v_mfma_f32_16x16x32_bf16 v[168:171], a[80:83], v[32:35], v[168:171]
    v_mfma_f32_16x16x32_bf16 v[172:175], a[80:83], v[96:99], v[172:175]
    buffer_load_dwordx4 a[52:55], v5, s[8:11], s16 offen offset:1024
    buffer_load_dwordx4 a[116:119], v5, s[8:11], s18 offen offset:1024
    ds_read_b128 v[48:51], v9 offset:8192
    ds_read_b128 v[112:115], v9 offset:24576
    s_waitcnt vmcnt(16) lgkmcnt(6)
    v_mfma_f32_16x16x32_bf16 v[160:163], a[20:23], v[36:39], v[160:163]
    v_mfma_f32_16x16x32_bf16 v[164:167], a[20:23], v[100:103], v[164:167]
    v_mfma_f32_16x16x32_bf16 v[168:171], a[84:87], v[36:39], v[168:171]
    v_mfma_f32_16x16x32_bf16 v[172:175], a[84:87], v[100:103], v[172:175]
    buffer_load_dwordx4 a[56:59], v5, s[8:11], s16 offen offset:2048
    buffer_load_dwordx4 a[120:123], v5, s[8:11], s18 offen offset:2048
    ds_read_b128 v[52:55], v9 offset:9216
    ds_read_b128 v[116:119], v9 offset:25600
    s_waitcnt vmcnt(16) lgkmcnt(6)
    v_mfma_f32_16x16x32_bf16 v[160:163], a[24:27], v[40:43], v[160:163]
    v_mfma_f32_16x16x32_bf16 v[164:167], a[24:27], v[104:107], v[164:167]
    v_mfma_f32_16x16x32_bf16 v[168:171], a[88:91], v[40:43], v[168:171]
    v_mfma_f32_16x16x32_bf16 v[172:175], a[88:91], v[104:107], v[172:175]
    buffer_load_dwordx4 a[60:63], v5, s[8:11], s16 offen offset:3072
    buffer_load_dwordx4 a[124:127], v5, s[8:11], s18 offen offset:3072
    v_add_u32 v5, 4096, v5
    buffer_load_ushort v144, v8, s[8:11], s20 offen offset:0
    buffer_load_ushort v148, v8, s[8:11], s20 offen offset:32
    v_add_u32 v8, 4096, v8
    buffer_load_ushort v145, v8, s[8:11], s20 offen offset:0
    buffer_load_ushort v149, v8, s[8:11], s20 offen offset:32
    v_add_u32 v8, 4096, v8
    buffer_load_ushort v146, v8, s[8:11], s20 offen offset:0
    buffer_load_ushort v150, v8, s[8:11], s20 offen offset:32
    v_add_u32 v8, 4096, v8
    buffer_load_ushort v147, v8, s[8:11], s20 offen offset:0
    buffer_load_ushort v151, v8, s[8:11], s20 offen offset:32
    v_add_u32 v8, 53248, v8
    buffer_load_ushort v152, v8, s[8:11], s20 offen offset:0
    buffer_load_ushort v156, v8, s[8:11], s20 offen offset:32
    v_add_u32 v8, 4096, v8
    buffer_load_ushort v153, v8, s[8:11], s20 offen offset:0
    buffer_load_ushort v157, v8, s[8:11], s20 offen offset:32
    v_add_u32 v8, 4096, v8
    buffer_load_ushort v154, v8, s[8:11], s20 offen offset:0
    buffer_load_ushort v158, v8, s[8:11], s20 offen offset:32
    v_add_u32 v8, 4096, v8
    buffer_load_ushort v155, v8, s[8:11], s20 offen offset:0
    buffer_load_ushort v159, v8, s[8:11], s20 offen offset:32
    v_add_u32 v8, 53248, v8
    ds_read_b128 v[56:59], v9 offset:10240
    ds_read_b128 v[120:123], v9 offset:26624
    s_waitcnt vmcnt(32) lgkmcnt(6)
    v_mfma_f32_16x16x32_bf16 v[160:163], a[28:31], v[44:47], v[160:163]
    v_mfma_f32_16x16x32_bf16 v[164:167], a[28:31], v[108:111], v[164:167]
    v_mfma_f32_16x16x32_bf16 v[168:171], a[92:95], v[44:47], v[168:171]
    v_mfma_f32_16x16x32_bf16 v[172:175], a[92:95], v[108:111], v[172:175]
    ds_read_b128 v[60:63], v9 offset:11264
    ds_read_b128 v[124:127], v9 offset:27648
    s_waitcnt vmcnt(30) lgkmcnt(6)
    v_mfma_f32_16x16x32_bf16 v[160:163], a[32:35], v[48:51], v[160:163]
    v_mfma_f32_16x16x32_bf16 v[164:167], a[32:35], v[112:115], v[164:167]
    v_mfma_f32_16x16x32_bf16 v[168:171], a[96:99], v[48:51], v[168:171]
    v_mfma_f32_16x16x32_bf16 v[172:175], a[96:99], v[112:115], v[172:175]
    ds_read_b128 v[64:67], v9 offset:12288
    ds_read_b128 v[128:131], v9 offset:28672
    s_waitcnt vmcnt(28) lgkmcnt(6)
    v_mfma_f32_16x16x32_bf16 v[160:163], a[36:39], v[52:55], v[160:163]
    v_mfma_f32_16x16x32_bf16 v[164:167], a[36:39], v[116:119], v[164:167]
    v_mfma_f32_16x16x32_bf16 v[168:171], a[100:103], v[52:55], v[168:171]
    v_mfma_f32_16x16x32_bf16 v[172:175], a[100:103], v[116:119], v[172:175]
    ds_read_b128 v[68:71], v9 offset:13312
    ds_read_b128 v[132:135], v9 offset:29696
    s_waitcnt vmcnt(26) lgkmcnt(6)
    v_mfma_f32_16x16x32_bf16 v[160:163], a[40:43], v[56:59], v[160:163]
    v_mfma_f32_16x16x32_bf16 v[164:167], a[40:43], v[120:123], v[164:167]
    v_mfma_f32_16x16x32_bf16 v[168:171], a[104:107], v[56:59], v[168:171]
    v_mfma_f32_16x16x32_bf16 v[172:175], a[104:107], v[120:123], v[172:175]
    ds_read_b128 v[72:75], v9 offset:14336
    ds_read_b128 v[136:139], v9 offset:30720
    s_waitcnt vmcnt(24) lgkmcnt(6)
    v_mfma_f32_16x16x32_bf16 v[160:163], a[44:47], v[60:63], v[160:163]
    v_mfma_f32_16x16x32_bf16 v[164:167], a[44:47], v[124:127], v[164:167]
    v_mfma_f32_16x16x32_bf16 v[168:171], a[108:111], v[60:63], v[168:171]
    v_mfma_f32_16x16x32_bf16 v[172:175], a[108:111], v[124:127], v[172:175]
    ds_read_b128 v[76:79], v9 offset:15360
    ds_read_b128 v[140:143], v9 offset:31744
    s_waitcnt vmcnt(22) lgkmcnt(6)
    v_mfma_f32_16x16x32_bf16 v[160:163], a[48:51], v[64:67], v[160:163]
    v_mfma_f32_16x16x32_bf16 v[164:167], a[48:51], v[128:131], v[164:167]
    v_mfma_f32_16x16x32_bf16 v[168:171], a[112:115], v[64:67], v[168:171]
    v_mfma_f32_16x16x32_bf16 v[172:175], a[112:115], v[128:131], v[172:175]
    s_waitcnt vmcnt(20) lgkmcnt(4)
    v_mfma_f32_16x16x32_bf16 v[160:163], a[52:55], v[68:71], v[160:163]
    v_mfma_f32_16x16x32_bf16 v[164:167], a[52:55], v[132:135], v[164:167]
    v_mfma_f32_16x16x32_bf16 v[168:171], a[116:119], v[68:71], v[168:171]
    v_mfma_f32_16x16x32_bf16 v[172:175], a[116:119], v[132:135], v[172:175]
    s_waitcnt vmcnt(18) lgkmcnt(2)
    v_mfma_f32_16x16x32_bf16 v[160:163], a[56:59], v[72:75], v[160:163]
    v_mfma_f32_16x16x32_bf16 v[164:167], a[56:59], v[136:139], v[164:167]
    v_mfma_f32_16x16x32_bf16 v[168:171], a[120:123], v[72:75], v[168:171]
    v_mfma_f32_16x16x32_bf16 v[172:175], a[120:123], v[136:139], v[172:175]
    s_waitcnt vmcnt(16) lgkmcnt(0)
    v_mfma_f32_16x16x32_bf16 v[160:163], a[60:63], v[76:79], v[160:163]
    v_mfma_f32_16x16x32_bf16 v[164:167], a[60:63], v[140:143], v[164:167]
    v_mfma_f32_16x16x32_bf16 v[168:171], a[124:127], v[76:79], v[168:171]
    v_mfma_f32_16x16x32_bf16 v[172:175], a[124:127], v[140:143], v[172:175]
    v_add_u32 v8, s5, v3
    v_lshlrev_b32 v8, 10, v8
    v_lshl_add_u32 v8, v4, 3, v8
    v_add_u32 v9, 16384, v8
    s_lshl_b32 s16, s7, 1
    s_nop 7
    s_waitcnt vmcnt(0)
    v_cvt_pk_bf16_f32 v160, v160, v160
    v_lshlrev_b32 v160, 16, v160
    v_lshlrev_b32 v144, 16, v144
    v_add_f32 v160, v160, v144
    v_cvt_pk_bf16_f32 v161, v161, v161
    v_lshlrev_b32 v161, 16, v161
    v_lshlrev_b32 v145, 16, v145
    v_add_f32 v161, v161, v145
    v_cvt_pk_bf16_f32 v162, v162, v162
    v_lshlrev_b32 v162, 16, v162
    v_lshlrev_b32 v146, 16, v146
    v_add_f32 v162, v162, v146
    v_cvt_pk_bf16_f32 v163, v163, v163
    v_lshlrev_b32 v163, 16, v163
    v_lshlrev_b32 v147, 16, v147
    v_add_f32 v163, v163, v147
    v_cvt_pk_bf16_f32 v164, v164, v164
    v_lshlrev_b32 v164, 16, v164
    v_lshlrev_b32 v148, 16, v148
    v_add_f32 v164, v164, v148
    v_cvt_pk_bf16_f32 v165, v165, v165
    v_lshlrev_b32 v165, 16, v165
    v_lshlrev_b32 v149, 16, v149
    v_add_f32 v165, v165, v149
    v_cvt_pk_bf16_f32 v166, v166, v166
    v_lshlrev_b32 v166, 16, v166
    v_lshlrev_b32 v150, 16, v150
    v_add_f32 v166, v166, v150
    v_cvt_pk_bf16_f32 v167, v167, v167
    v_lshlrev_b32 v167, 16, v167
    v_lshlrev_b32 v151, 16, v151
    v_add_f32 v167, v167, v151
    v_cvt_pk_bf16_f32 v168, v168, v168
    v_lshlrev_b32 v168, 16, v168
    v_lshlrev_b32 v152, 16, v152
    v_add_f32 v168, v168, v152
    v_cvt_pk_bf16_f32 v169, v169, v169
    v_lshlrev_b32 v169, 16, v169
    v_lshlrev_b32 v153, 16, v153
    v_add_f32 v169, v169, v153
    v_cvt_pk_bf16_f32 v170, v170, v170
    v_lshlrev_b32 v170, 16, v170
    v_lshlrev_b32 v154, 16, v154
    v_add_f32 v170, v170, v154
    v_cvt_pk_bf16_f32 v171, v171, v171
    v_lshlrev_b32 v171, 16, v171
    v_lshlrev_b32 v155, 16, v155
    v_add_f32 v171, v171, v155
    v_cvt_pk_bf16_f32 v172, v172, v172
    v_lshlrev_b32 v172, 16, v172
    v_lshlrev_b32 v156, 16, v156
    v_add_f32 v172, v172, v156
    v_cvt_pk_bf16_f32 v173, v173, v173
    v_lshlrev_b32 v173, 16, v173
    v_lshlrev_b32 v157, 16, v157
    v_add_f32 v173, v173, v157
    v_cvt_pk_bf16_f32 v174, v174, v174
    v_lshlrev_b32 v174, 16, v174
    v_lshlrev_b32 v158, 16, v158
    v_add_f32 v174, v174, v158
    v_cvt_pk_bf16_f32 v175, v175, v175
    v_lshlrev_b32 v175, 16, v175
    v_lshlrev_b32 v159, 16, v159
    v_add_f32 v175, v175, v159
    v_cvt_pk_bf16_f32 v10, v160, v161
    v_cvt_pk_bf16_f32 v11, v162, v163
    buffer_store_dwordx2 v[10:11], v8, s[12:15], s16 offen offset:0
    s_nop 0
    v_cvt_pk_bf16_f32 v12, v164, v165
    v_cvt_pk_bf16_f32 v13, v166, v167
    buffer_store_dwordx2 v[12:13], v9, s[12:15], s16 offen offset:0
    s_nop 0
    v_cvt_pk_bf16_f32 v10, v168, v169
    v_cvt_pk_bf16_f32 v11, v170, v171
    buffer_store_dwordx2 v[10:11], v8, s[12:15], s16 offen offset:32
    s_nop 0
    v_cvt_pk_bf16_f32 v12, v172, v173
    v_cvt_pk_bf16_f32 v13, v174, v175
    buffer_store_dwordx2 v[12:13], v9, s[12:15], s16 offen offset:32
    s_nop 0
L_end_oproj2_kernel:
    s_endpgm
.section .rodata,"a"
.p2align 6
.amdhsa_kernel oproj2_kernel
  .amdhsa_next_free_vgpr 304
  .amdhsa_next_free_sgpr 96
  .amdhsa_accum_offset 176
  .amdhsa_group_segment_fixed_size 0
  .amdhsa_kernarg_size 120
  .amdhsa_user_sgpr_count 2
  .amdhsa_user_sgpr_kernarg_segment_ptr 1
  .amdhsa_system_sgpr_workgroup_id_x 1
.end_amdhsa_kernel
.text
```
